```python
import torch

def _softmax(x, axis=-1):
    return torch.softmax(x, dim=axis)
def _gelu(x):
    return torch.nn.functional.gelu(x, approximate="tanh")
def _silu(x):
    return torch.nn.functional.silu(x)
def _sigmoid(x):
    return torch.sigmoid(x)
def _layernorm(x, axis=-1, eps=1e-5):
    m = x.mean(dim=axis, keepdim=True)
    v = x.var(dim=axis, keepdim=True, unbiased=False)
    return (x - m) / torch.sqrt(v + eps)
def _scatter_add(tgt, idx, src, axis=0):
    return tgt.clone().index_add_(axis, idx, src)
def _segment_sum(src, seg, n):
    out = torch.zeros((n,) + src.shape[1:], dtype=src.dtype)
    return out.index_add_(0, seg, src)
def _pad(x, pw):
    flat = tuple(v for pair in reversed(pw) for v in pair)
    return torch.nn.functional.pad(x, flat)

kernel_name = 'recurrent_scan__sliding_block_cached__swiglu_ffn__decode'

def setup_inputs():

    _w = (lambda a: (lambda t: t.to(torch.bfloat16) if t.is_floating_point() else t)(torch.as_tensor(a)))
    def _A_setup():
        B, Sq, D = 1, 1, 448
        Hq, Hkv, Sk, Dh = 16, 8, 65536, 256
        assert Hq % Hkv == 0, (Hq, Hkv)
        return {
            "x": _w((lambda *s: torch.randn(*s, dtype=torch.bfloat16) * 0.05)(B, Sq, D)),
            "k_cache": _w((lambda *s: torch.randn(*s, dtype=torch.bfloat16) * 1.6)(B, Hkv, Sk, Dh)),
            "v_cache": _w((lambda *s: torch.randn(*s, dtype=torch.bfloat16) * 0.2)(B, Hkv, Sk, Dh)),
            "wq": _w((lambda *s: torch.randn(*s, dtype=torch.bfloat16) * 1.6)(D, Hq * Dh) * (D ** -0.5)),
            "wo": _w((lambda *s: torch.randn(*s, dtype=torch.bfloat16) * 0.2)(Hq * Dh, D) * ((Hq * Dh) ** -0.5)),
        }
    _A_in = _A_setup()

    def _B_setup():
        B, S, D, F = 1, 1, 448, 1792
        return {
            "x": _w((lambda *s: torch.randn(*s, dtype=torch.bfloat16) * 0.05)(B, S, D)),
            "w_gate": _w((lambda *s: torch.randn(*s, dtype=torch.bfloat16) * 0.1)(D, F)),
            "w_up": _w((lambda *s: torch.randn(*s, dtype=torch.bfloat16) * 0.1)(D, F)),
            "w_down": _w((lambda *s: torch.randn(*s, dtype=torch.bfloat16) * 0.1)(F, D)),
        }
    _B_in = _B_setup()

    return {
        "A_x": _A_in["x"],
        "A_k_cache": _A_in["k_cache"],
        "A_v_cache": _A_in["v_cache"],
        "A_wq": _A_in["wq"],
        "A_wo": _A_in["wo"],
        "B_x": _B_in["x"],
        "B_w_gate": _B_in["w_gate"],
        "B_w_up": _B_in["w_up"],
        "B_w_down": _B_in["w_down"],
    }

def reference(A_x, A_k_cache, A_v_cache, A_wq, A_wo, B_x, B_w_gate, B_w_up, B_w_down):
    def _A_ref(x, k_cache, v_cache, wq, wo):
        B, Sq, D = x.shape
        Hq, Dh = 16, 256
        Hkv, Sk = k_cache.shape[1], k_cache.shape[2]
        W = min(4096, max(256, Sk // 4))
        rep = Hq // Hkv
        q = (lambda x, *d: x.permute(*d))((x @ wq).reshape(B, Sq, Hq, Dh), 0, 2, 1, 3)
        k = (lambda x, n, axis: torch.repeat_interleave(x, n, dim=axis))(k_cache[:, :, Sk - W:, :], rep, axis=1)
        v = (lambda x, n, axis: torch.repeat_interleave(x, n, dim=axis))(v_cache[:, :, Sk - W:, :], rep, axis=1)
        scores = torch.einsum("bhqd,bhkd->bhqk", q, k) * (Dh ** -0.5)
        p = _softmax(scores, axis=-1)
        o = torch.einsum("bhqk,bhkd->bhqd", p, v)
        return (lambda x, *d: x.permute(*d))(o, 0, 2, 1, 3).reshape(B, Sq, Hq * Dh) @ wo

    def _B_ref(x, w_gate, w_up, w_down):
        g = _silu(x @ w_gate)
        u = x @ w_up
        return (g * u) @ w_down

    x = A_x
    xn = _layernorm(x, axis=-1)
    s = _A_ref(xn, A_k_cache, A_v_cache, A_wq, A_wo)
    g = _silu(_B_ref(xn, B_w_gate, B_w_up, B_w_down))
    return x + s * g
```

```asm
; @launch grid=(256,1,1) block=(768,1,1) lds=20480
.amdgcn_target "amdgcn-amd-amdhsa--gfx950"
.text
.globl recurrent_scan__sliding_block_cached__swiglu_ffn__decode_kernel
.p2align 12
.type recurrent_scan__sliding_block_cached__swiglu_ffn__decode_kernel,@function
recurrent_scan__sliding_block_cached__swiglu_ffn__decode_kernel:
    s_cmp_ge_u32 s2, 256
    s_cbranch_scc1 L_end
    s_load_dwordx16 s[4:19], s[0:1], 0
    s_load_dwordx8 s[20:27], s[0:1], 64
    v_lshrrev_b32 v4, 6, v0
    v_and_b32 v1, 63, v0
    v_readfirstlane_b32 s3, v4
    v_and_b32 v2, 15, v1
    v_lshrrev_b32 v3, 4, v1
    s_and_b32 s29, s2, 7
    s_lshr_b32 s30, s2, 3
    v_mov_b32 v60, 0xffffff00
    v_mov_b32 v61, 0
    v_mov_b32 v62, 1
    s_mov_b32 s35, 0x20000
    s_mov_b32 s39, 0x20000
    s_mov_b32 s42, 4194304
    s_mov_b32 s43, 0x20000
    s_mov_b32 s55, 0x3db8aa3b
    s_cmp_lg_u32 s3, 0
    s_cbranch_scc1 L_notH0
    s_setprio 3
    s_mov_b32 s38, 896
    v_mul_u32_u24 v5, 56, v3
    v_lshrrev_b32 v6, 3, v2
    v_add_u32 v5, v5, v6
    v_and_b32 v6, 7, v2
    v_lshlrev_b32 v6, 4, v6
    v_lshlrev_b32 v7, 4, v1
    s_xor_b32 s79, s30, 0
    s_and_b32 s57, s30, 1
    s_mul_i32 s63, s57, 224
    v_add_u32 v5, s63, v5
    s_cmp_lt_u32 s79, 16
    s_cbranch_scc0 L_gu
    s_lshr_b32 s58, s79, 1
    s_lshl_b32 s59, s29, 3
    s_add_u32 s59, s59, s58
    s_mov_b32 s56, 16384
    s_mov_b32 s34, 3670016
    s_lshl_b32 s62, s29, 12
    s_lshl_b32 s63, s57, 11
    s_add_u32 s62, s62, s63
    s_lshl_b32 s63, s58, 8
    s_add_u32 s62, s62, s63
    s_add_u32 s62, s62, 2363392
    v_lshl_add_u32 v5, v5, 13, v6
    s_waitcnt lgkmcnt(0)
    s_mov_b32 s32, s10
    s_mov_b32 s33, s11
    s_branch L_task
L_gu:
    s_mul_i32 s59, s29, 7
    s_sub_u32 s58, s79, 16
    s_lshr_b32 s58, s58, 1
    s_add_u32 s59, s59, s58
    s_mov_b32 s56, 7168
    s_cmp_lt_u32 s79, 30
    s_cselect_b32 s34, 1605632, 0
    s_cmp_ge_u32 s59, 28
    s_cselect_b32 s58, 2, 0
    s_cselect_b32 s63, 28, 0
    s_sub_u32 s59, s59, s63
    s_add_u32 s62, s58, s57
    s_mul_i32 s62, s62, 7168
    s_lshl_b32 s63, s59, 8
    s_add_u32 s62, s62, s63
    s_add_u32 s62, s62, 69632
    v_mul_u32_u24 v5, 3584, v5
    v_add_u32 v5, v5, v6
    s_waitcnt lgkmcnt(0)
    s_cmp_eq_u32 s58, 2
    s_cselect_b32 s32, s18, s16
    s_cselect_b32 s33, s19, s17
L_task:
    s_mov_b32 s36, s4
    s_mov_b32 s37, s5
    s_lshl_b32 s59, s59, 7
    buffer_load_dwordx4 v[8:11], v7, s[36:39], 0 offen
    buffer_load_dwordx4 v[56:59], v5, s[32:35], s59 offen nt
    s_add_u32 s59, s59, s56
    buffer_load_dwordx4 v[60:63], v5, s[32:35], s59 offen nt
    s_add_u32 s59, s59, s56
    buffer_load_dwordx4 v[64:67], v5, s[32:35], s59 offen nt
    s_add_u32 s59, s59, s56
    buffer_load_dwordx4 v[68:71], v5, s[32:35], s59 offen nt
    s_add_u32 s59, s59, s56
    buffer_load_dwordx4 v[72:75], v5, s[32:35], s59 offen nt
    s_add_u32 s59, s59, s56
    buffer_load_dwordx4 v[76:79], v5, s[32:35], s59 offen nt
    s_add_u32 s59, s59, s56
    buffer_load_dwordx4 v[80:83], v5, s[32:35], s59 offen nt
    s_add_u32 s59, s59, s56
    buffer_load_dwordx4 v[84:87], v5, s[32:35], s59 offen nt
    s_add_u32 s59, s59, s56
    buffer_load_dwordx4 v[88:91], v5, s[32:35], s59 offen nt
    s_add_u32 s59, s59, s56
    buffer_load_dwordx4 v[92:95], v5, s[32:35], s59 offen nt
    s_add_u32 s59, s59, s56
    buffer_load_dwordx4 v[96:99], v5, s[32:35], s59 offen nt
    s_add_u32 s59, s59, s56
    buffer_load_dwordx4 v[100:103], v5, s[32:35], s59 offen nt
    s_add_u32 s59, s59, s56
    buffer_load_dwordx4 v[104:107], v5, s[32:35], s59 offen nt
    s_add_u32 s59, s59, s56
    buffer_load_dwordx4 v[108:111], v5, s[32:35], s59 offen nt
    s_add_u32 s59, s59, s56
    buffer_load_dwordx4 v[112:115], v5, s[32:35], s59 offen nt
    s_add_u32 s59, s59, s56
    buffer_load_dwordx4 v[116:119], v5, s[32:35], s59 offen nt
    s_add_u32 s59, s59, s56
    buffer_load_dwordx4 v[120:123], v5, s[32:35], s59 offen nt
    s_add_u32 s59, s59, s56
    buffer_load_dwordx4 v[124:127], v5, s[32:35], s59 offen nt
    s_add_u32 s59, s59, s56
    buffer_load_dwordx4 v[128:131], v5, s[32:35], s59 offen nt
    s_add_u32 s59, s59, s56
    buffer_load_dwordx4 v[132:135], v5, s[32:35], s59 offen nt
    s_add_u32 s59, s59, s56
    buffer_load_dwordx4 v[136:139], v5, s[32:35], s59 offen nt
    s_add_u32 s59, s59, s56
    buffer_load_dwordx4 v[140:143], v5, s[32:35], s59 offen nt
    s_add_u32 s59, s59, s56
    buffer_load_dwordx4 v[144:147], v5, s[32:35], s59 offen nt
    s_add_u32 s59, s59, s56
    buffer_load_dwordx4 v[148:151], v5, s[32:35], s59 offen nt
    s_add_u32 s59, s59, s56
    buffer_load_dwordx4 v[152:155], v5, s[32:35], s59 offen nt
    s_add_u32 s59, s59, s56
    buffer_load_dwordx4 v[156:159], v5, s[32:35], s59 offen nt
    s_add_u32 s59, s59, s56
    buffer_load_dwordx4 v[160:163], v5, s[32:35], s59 offen nt
    s_add_u32 s59, s59, s56
    buffer_load_dwordx4 v[164:167], v5, s[32:35], s59 offen nt
    s_load_dword s28, s[26:27], 0
    s_barrier
    s_mov_b32 s40, s26
    s_mov_b32 s41, s27
    s_branch L_H0b
L_stub0:
    s_branch L_ret
L_notH0:
    s_cmp_eq_u32 s3, 1
    s_cbranch_scc1 L_stub9
    s_cmp_eq_u32 s3, 2
    s_cbranch_scc1 L_stub2
    s_cmp_eq_u32 s3, 3
    s_cbranch_scc1 L_stub10
    s_cmp_eq_u32 s3, 4
    s_cbranch_scc1 L_stub0
    s_cmp_eq_u32 s3, 5
    s_cbranch_scc1 L_stub1
    s_cmp_eq_u32 s3, 6
    s_cbranch_scc1 L_stub11
    s_cmp_eq_u32 s3, 7
    s_cbranch_scc1 L_stub12
    s_cmp_eq_u32 s3, 8
    s_cbranch_scc1 L_stub5
    s_cmp_eq_u32 s3, 9
    s_cbranch_scc1 L_stub6
    s_cmp_eq_u32 s3, 10
    s_cbranch_scc1 L_stub7
    s_cmp_eq_u32 s3, 11
    s_cbranch_scc1 L_stub8
L_ret:
    s_cmp_lt_u32 s3, 4
    s_cbranch_scc1 L_H123
    s_sub_u32 s3, s3, 4
    s_lshl_b32 s52, s29, 25
    s_add_u32 s52, s52, 0x1e00000
    s_lshl_b32 s53, s30, 16
    s_add_u32 s52, s52, s53
    s_lshl_b32 s53, s3, 13
    s_add_u32 s52, s52, s53
    s_mov_b32 s34, 0x2000
    s_mov_b32 s38, 0x2000
    s_movk_i32 s54, 0x1000
    v_lshrrev_b32 v4, 2, v2
    v_lshlrev_b32 v4, 9, v4
    v_lshl_add_u32 v4, v3, 6, v4
    v_and_b32 v6, 3, v2
    v_lshl_add_u32 v4, v6, 4, v4
    v_lshlrev_b32 v5, 9, v3
    v_lshl_add_u32 v5, v2, 4, v5
    s_mov_b32 s31, 0
    s_mov_b32 s46, 0
    s_mov_b32 s56, 0
    s_mov_b32 s57, 0
    s_mov_b32 s47, 0x20000
    s_mov_b32 s65, 0
    s_waitcnt lgkmcnt(0)
    s_add_u32 s32, s6, s52
    s_addc_u32 s33, s7, 0
    s_add_u32 s36, s8, s52
    s_addc_u32 s37, s9, 0
    s_mov_b32 s44, s12
    s_mov_b32 s45, s13
    s_mov_b32 s40, s26
    s_mov_b32 s41, s27
    s_cmp_ge_u32 s30, 23
    s_cbranch_scc1 L_Anp
    s_cmp_ge_u32 s3, 7
    s_cbranch_scc1 L_Anp
    s_mov_b32 s31, 1
    s_load_dword s28, s[26:27], 0
    s_cmp_ge_u32 s30, 16
    s_cbranch_scc1 L_Adn
    s_lshl_b32 s56, s29, 4
    s_add_u32 s56, s56, s30
    s_mov_b32 s57, s56
    s_mov_b32 s46, 3670016
    s_branch L_Anp
L_Adn:
    s_mul_i32 s57, s29, 7
    s_add_u32 s57, s57, s30
    s_sub_u32 s57, s57, 16
    s_add_u32 s56, s57, 128
    s_mov_b32 s44, s20
    s_mov_b32 s45, s21
    s_mov_b32 s46, 1605632
L_Anp:
    s_barrier
    buffer_load_dwordx4 v[64:67], v4, s[32:35], 0 offen offset:0 nt
    buffer_load_dwordx4 v[68:71], v4, s[32:35], 0 offen offset:256 nt
    buffer_load_dwordx4 v[72:75], v4, s[32:35], 0 offen offset:2048 nt
    s_cmp_eq_u32 s3, 0
    s_cbranch_scc1 L_stub3
    s_cmp_eq_u32 s3, 1
    s_cbranch_scc1 L_stub4
    s_cmp_eq_u32 s3, 2
    s_cbranch_scc1 L_stub13
    s_cmp_eq_u32 s3, 3
    s_cbranch_scc1 L_stub14
    s_cmp_eq_u32 s3, 4
    s_cbranch_scc1 L_stub15
    s_cmp_eq_u32 s3, 5
    s_cbranch_scc1 L_stub16
    s_cmp_eq_u32 s3, 6
    s_cbranch_scc1 L_stub17
    s_cmp_eq_u32 s3, 7
    s_cbranch_scc1 L_ret2
L_ret2:
    s_waitcnt vmcnt(2)
    buffer_load_dwordx4 v[76:79], v4, s[32:35], 0 offen offset:2304 nt
    v_and_b32 v6, 1, v2
    v_mov_b32 v7, 0xffff
    v_lshlrev_b32 v6, 4, v6
    v_lshlrev_b32 v7, v6, v7
    v_bfe_u32 v6, v2, 1, 2
    v_cmp_eq_u32 vcc, 0, v6
    s_nop 1
    v_cndmask_b32 v8, 0, v7, vcc
    v_cmp_eq_u32 vcc, 1, v6
    s_nop 1
    v_cndmask_b32 v9, 0, v7, vcc
    v_cmp_eq_u32 vcc, 2, v6
    s_nop 1
    v_cndmask_b32 v10, 0, v7, vcc
    v_cmp_eq_u32 vcc, 3, v6
    s_nop 1
    v_cndmask_b32 v11, 0, v7, vcc
    v_lshrrev_b32 v6, 3, v2
    v_lshlrev_b32 v6, 9, v6
    v_lshl_add_u32 v6, v3, 6, v6
    v_and_b32 v7, 3, v2
    v_lshl_add_u32 v6, v7, 4, v6
    v_lshrrev_b32 v7, 1, v3
    v_lshlrev_b32 v7, 10, v7
    v_lshl_add_u32 v7, v2, 5, v7
    v_and_b32 v44, 1, v3
    v_lshl_add_u32 v7, v44, 4, v7
    s_lshl_b32 s53, s3, 11
    v_add_u32 v7, s53, v7
    v_lshrrev_b32 v45, 3, v2
    v_lshlrev_b32 v45, 3, v45
    s_lshl_b32 s53, s3, 4
    v_add_u32 v45, s53, v45
    v_lshrrev_b32 v59, 3, v2
    v_lshl_add_u32 v59, v3, 1, v59
    v_lshlrev_b32 v46, 4, v59
    v_mul_u32_u24 v59, 896, v59
    v_and_b32 v47, 7, v2
    v_lshl_add_u32 v59, v47, 4, v59
    v_lshlrev_b32 v63, 5, v2
    v_lshl_add_u32 v63, v44, 4, v63
    v_lshrrev_b32 v47, 1, v3
    v_lshl_add_u32 v63, v47, 13, v63
    s_mul_i32 s58, s57, 28672
    s_lshl_b32 s59, s3, 7
    s_add_u32 s58, s58, s59
    s_lshr_b32 s62, s56, 5
    s_lshl_b32 s62, s62, 14
    s_and_b32 s63, s56, 31
    s_lshl_b32 s63, s63, 8
    s_add_u32 s62, s62, s63
    s_lshl_b32 s63, s3, 17
    s_add_u32 s62, s62, s63
    s_sub_u32 s63, 0, s40
    s_and_b32 s63, s63, 0x3fff
    s_add_u32 s62, s62, s63
    s_add_u32 s62, s62, 720896
    s_branch L_skip1
L_stub1:
    s_branch L_ret
L_skip1:
    ds_read_b32 v44, v61 offset:3080
    s_waitcnt lgkmcnt(0)
    v_readfirstlane_b32 s53, v44
    s_cmp_ge_u32 s53, 16
    s_cbranch_scc1 L_f4
    s_waitcnt vmcnt(2)
    buffer_load_dwordx4 v[80:83], v4, s[32:35], s54 offen offset:0 nt
    ds_read_b32 v44, v61 offset:3080
    s_waitcnt lgkmcnt(0)
    v_readfirstlane_b32 s53, v44
    s_cmp_ge_u32 s53, 16
    s_cbranch_scc1 L_f5
    s_waitcnt vmcnt(2)
    buffer_load_dwordx4 v[84:87], v4, s[32:35], s54 offen offset:256 nt
    ds_read_b32 v44, v61 offset:3080
    s_waitcnt lgkmcnt(0)
    v_readfirstlane_b32 s53, v44
    s_cmp_ge_u32 s53, 16
    s_cbranch_scc1 L_f6
    s_waitcnt vmcnt(2)
    buffer_load_dwordx4 v[88:91], v4, s[32:35], s54 offen offset:2048 nt
    ds_read_b32 v44, v61 offset:3080
    s_waitcnt lgkmcnt(0)
    v_readfirstlane_b32 s53, v44
    s_cmp_ge_u32 s53, 16
    s_cbranch_scc1 L_f7
    s_waitcnt vmcnt(2)
    buffer_load_dwordx4 v[92:95], v4, s[32:35], s54 offen offset:2304 nt
    s_mov_b64 exec, 1
    ds_add_u32 v61, v62 offset:3104
    s_mov_b64 exec, -1
    ds_read_b32 v44, v61 offset:3080
    s_waitcnt lgkmcnt(0)
    v_readfirstlane_b32 s53, v44
    s_cmp_ge_u32 s53, 16
    s_mov_b32 s66, 8
    s_cbranch_scc1 L_gate
    s_waitcnt vmcnt(2)
    buffer_load_dwordx4 v[96:99], v5, s[36:39], 0 offen offset:0 nt
    ds_read_b32 v44, v61 offset:3080
    s_waitcnt lgkmcnt(0)
    v_readfirstlane_b32 s53, v44
    s_cmp_ge_u32 s53, 16
    s_mov_b32 s66, 9
    s_cbranch_scc1 L_gate
    s_waitcnt vmcnt(2)
    buffer_load_dwordx4 v[100:103], v5, s[36:39], 0 offen offset:256 nt
    ds_read_b32 v44, v61 offset:3080
    s_waitcnt lgkmcnt(0)
    v_readfirstlane_b32 s53, v44
    s_cmp_ge_u32 s53, 16
    s_mov_b32 s66, 10
    s_cbranch_scc1 L_gate
    s_waitcnt vmcnt(2)
    buffer_load_dwordx4 v[104:107], v5, s[36:39], 0 offen offset:2048 nt
    ds_read_b32 v44, v61 offset:3080
    s_waitcnt lgkmcnt(0)
    v_readfirstlane_b32 s53, v44
    s_cmp_ge_u32 s53, 16
    s_mov_b32 s66, 11
    s_cbranch_scc1 L_gate
    s_waitcnt vmcnt(2)
    buffer_load_dwordx4 v[108:111], v5, s[36:39], 0 offen offset:2304 nt
    ds_read_b32 v44, v61 offset:3080
    s_waitcnt lgkmcnt(0)
    v_readfirstlane_b32 s53, v44
    s_cmp_ge_u32 s53, 16
    s_mov_b32 s66, 12
    s_cbranch_scc1 L_gate
    s_waitcnt vmcnt(2)
    buffer_load_dwordx4 v[112:115], v5, s[36:39], s54 offen offset:0 nt
    ds_read_b32 v44, v61 offset:3080
    s_waitcnt lgkmcnt(0)
    v_readfirstlane_b32 s53, v44
    s_cmp_ge_u32 s53, 16
    s_mov_b32 s66, 13
    s_cbranch_scc1 L_gate
    s_waitcnt vmcnt(2)
    buffer_load_dwordx4 v[116:119], v5, s[36:39], s54 offen offset:256 nt
    ds_read_b32 v44, v61 offset:3080
    s_waitcnt lgkmcnt(0)
    v_readfirstlane_b32 s53, v44
    s_cmp_ge_u32 s53, 16
    s_mov_b32 s66, 14
    s_cbranch_scc1 L_gate
    s_waitcnt vmcnt(2)
    buffer_load_dwordx4 v[120:123], v5, s[36:39], s54 offen offset:2048 nt
    ds_read_b32 v44, v61 offset:3080
    s_waitcnt lgkmcnt(0)
    v_readfirstlane_b32 s53, v44
    s_cmp_ge_u32 s53, 16
    s_mov_b32 s66, 15
    s_cbranch_scc1 L_gate
    s_waitcnt vmcnt(2)
    buffer_load_dwordx4 v[124:127], v5, s[36:39], s54 offen offset:2304 nt
    s_branch L_vi
L_f4:
    buffer_load_dwordx4 v[80:83], v4, s[32:35], s54 offen offset:0 nt
L_f5:
    buffer_load_dwordx4 v[84:87], v4, s[32:35], s54 offen offset:256 nt
L_f6:
    buffer_load_dwordx4 v[88:91], v4, s[32:35], s54 offen offset:2048 nt
L_f7:
    buffer_load_dwordx4 v[92:95], v4, s[32:35], s54 offen offset:2304 nt
    s_mov_b64 exec, 1
    ds_add_u32 v61, v62 offset:3104
    s_mov_b64 exec, -1
    s_mov_b32 s66, 8
L_gate:
    s_mov_b32 s52, 2097152
L_spin1:
    ds_read_b32 v44, v61 offset:3104
    s_waitcnt lgkmcnt(0)
    v_readfirstlane_b32 s53, v44
    s_cmp_eq_u32 s53, 8
    s_cbranch_scc1 L_sok1
    s_sub_u32 s52, s52, 1
    s_cbranch_scc0 L_spin1
L_sok1:
    s_cmp_eq_u32 s66, 9
    s_cbranch_scc1 L_f9
    s_cmp_eq_u32 s66, 10
    s_cbranch_scc1 L_f10
    s_cmp_eq_u32 s66, 11
    s_cbranch_scc1 L_f11
    s_cmp_eq_u32 s66, 12
    s_cbranch_scc1 L_f12
    s_cmp_eq_u32 s66, 13
    s_cbranch_scc1 L_f13
    s_cmp_eq_u32 s66, 14
    s_cbranch_scc1 L_f14
    s_cmp_eq_u32 s66, 15
    s_cbranch_scc1 L_f15
L_f8:
    buffer_load_dwordx4 v[96:99], v5, s[36:39], 0 offen offset:0 nt
L_f9:
    buffer_load_dwordx4 v[100:103], v5, s[36:39], 0 offen offset:256 nt
L_f10:
    buffer_load_dwordx4 v[104:107], v5, s[36:39], 0 offen offset:2048 nt
L_f11:
    buffer_load_dwordx4 v[108:111], v5, s[36:39], 0 offen offset:2304 nt
L_f12:
    buffer_load_dwordx4 v[112:115], v5, s[36:39], s54 offen offset:0 nt
L_f13:
    buffer_load_dwordx4 v[116:119], v5, s[36:39], s54 offen offset:256 nt
L_f14:
    buffer_load_dwordx4 v[120:123], v5, s[36:39], s54 offen offset:2048 nt
L_f15:
    buffer_load_dwordx4 v[124:127], v5, s[36:39], s54 offen offset:2304 nt
L_vi:
    s_mov_b64 exec, 1
    ds_add_u32 v61, v62 offset:3084
    s_mov_b64 exec, -1
    s_mov_b32 s64, 0
    s_mov_b32 s66, 0
    s_mov_b32 s52, 0x400000
L_w:
    ds_read_b64 v[48:49], v61 offset:3080
    s_waitcnt lgkmcnt(0)
    v_readfirstlane_b32 s53, v49
    v_readfirstlane_b32 s59, v48
    s_cmp_lg_u32 s65, 0
    s_cbranch_scc1 L_w1
    s_cmp_eq_u32 s59, 19
    s_cbranch_scc1 L_QKw
L_w1:
    s_cmp_lg_u32 s64, 0
    s_cbranch_scc1 L_w2
    s_cmp_lt_u32 s53, 8
    s_cbranch_scc1 L_w2
    s_mov_b32 s64, 1
    buffer_load_dwordx4 v[128:131], v59, s[44:47], s58 offen nt
    s_add_u32 s58, s58, 7168
    buffer_load_dwordx4 v[132:135], v59, s[44:47], s58 offen nt
    s_add_u32 s58, s58, 7168
    buffer_load_dwordx4 v[136:139], v59, s[44:47], s58 offen nt
    s_add_u32 s58, s58, 7168
    buffer_load_dwordx4 v[140:143], v59, s[44:47], s58 offen nt
L_w2:
    s_and_b32 s53, s64, s65
    s_cbranch_scc1 L_PV
L_w4:
    s_sub_u32 s52, s52, 1
    s_cbranch_scc0 L_w
    s_branch L_PV
L_stub2:
    s_branch L_ret
L_QKw:
    s_waitcnt vmcnt(12)
    s_cmp_lg_u32 s64, 0
    s_cbranch_scc1 L_QK
    s_waitcnt vmcnt(8)
L_QK:
    ds_read_b128 v[12:15], v6 offset:2048
    ds_read_b128 v[16:19], v6 offset:2304
    s_mov_b32 s65, 1
    s_waitcnt lgkmcnt(1)
    v_mfma_f32_16x16x32_bf16 v[20:23], v[64:67], v[12:15], 0
    v_mfma_f32_16x16x32_bf16 v[24:27], v[72:75], v[12:15], 0
    v_mfma_f32_16x16x32_bf16 v[28:31], v[80:83], v[12:15], 0
    v_mfma_f32_16x16x32_bf16 v[32:35], v[88:91], v[12:15], 0
    s_waitcnt lgkmcnt(0)
    v_mfma_f32_16x16x32_bf16 v[20:23], v[68:71], v[16:19], v[20:23]
    v_mfma_f32_16x16x32_bf16 v[24:27], v[76:79], v[16:19], v[24:27]
    v_mfma_f32_16x16x32_bf16 v[28:31], v[84:87], v[16:19], v[28:31]
    v_mfma_f32_16x16x32_bf16 v[32:35], v[92:95], v[16:19], v[32:35]
    s_nop 4
    v_mov_b32_dpp v36, v20 quad_perm:[0,0,0,0] row_mask:0xf bank_mask:0xf
    v_mov_b32_dpp v37, v24 quad_perm:[0,0,0,0] row_mask:0xf bank_mask:0xf
    v_mov_b32_dpp v38, v28 quad_perm:[0,0,0,0] row_mask:0xf bank_mask:0xf
    v_mov_b32_dpp v39, v32 quad_perm:[0,0,0,0] row_mask:0xf bank_mask:0xf
    v_add_f32_dpp v36, v21, v36 quad_perm:[1,1,1,1] row_mask:0xf bank_mask:0xf
    v_add_f32_dpp v37, v25, v37 quad_perm:[1,1,1,1] row_mask:0xf bank_mask:0xf
    v_add_f32_dpp v38, v29, v38 quad_perm:[1,1,1,1] row_mask:0xf bank_mask:0xf
    v_add_f32_dpp v39, v33, v39 quad_perm:[1,1,1,1] row_mask:0xf bank_mask:0xf
    v_add_f32_dpp v36, v22, v36 quad_perm:[2,2,2,2] row_mask:0xf bank_mask:0xf
    v_add_f32_dpp v37, v26, v37 quad_perm:[2,2,2,2] row_mask:0xf bank_mask:0xf
    v_add_f32_dpp v38, v30, v38 quad_perm:[2,2,2,2] row_mask:0xf bank_mask:0xf
    v_add_f32_dpp v39, v34, v39 quad_perm:[2,2,2,2] row_mask:0xf bank_mask:0xf
    v_add_f32_dpp v36, v23, v36 quad_perm:[3,3,3,3] row_mask:0xf bank_mask:0xf
    v_add_f32_dpp v37, v27, v37 quad_perm:[3,3,3,3] row_mask:0xf bank_mask:0xf
    v_add_f32_dpp v38, v31, v38 quad_perm:[3,3,3,3] row_mask:0xf bank_mask:0xf
    v_add_f32_dpp v39, v35, v39 quad_perm:[3,3,3,3] row_mask:0xf bank_mask:0xf
    v_cvt_pk_bf16_f32 v40, v36, v37
    v_cvt_pk_bf16_f32 v41, v38, v39
    v_lshlrev_b32 v36, 16, v40
    v_and_b32 v37, 0xffff0000, v40
    v_lshlrev_b32 v38, 16, v41
    v_and_b32 v39, 0xffff0000, v41
    v_max_f32 v56, v36, v37
    v_max3_f32 v56, v56, v38, v39
    v_mov_b32 v57, v56
    s_nop 1
    v_permlane16_swap_b32 v56, v57
    s_nop 0
    v_max_f32 v56, v56, v57
    v_mov_b32 v57, v56
    s_nop 1
    v_permlane32_swap_b32 v56, v57
    s_nop 0
    v_max_f32 v56, v56, v57
    v_sub_f32 v40, v36, v56
    v_sub_f32 v41, v37, v56
    v_sub_f32 v42, v38, v56
    v_sub_f32 v43, v39, v56
    v_mul_f32 v40, s55, v40
    v_mul_f32 v41, s55, v41
    v_mul_f32 v42, s55, v42
    v_mul_f32 v43, s55, v43
    v_exp_f32 v40, v40
    v_exp_f32 v41, v41
    v_exp_f32 v42, v42
    v_exp_f32 v43, v43
    s_nop 0
    v_add_f32 v57, v40, v41
    v_add_f32 v58, v42, v43
    v_add_f32 v57, v57, v58
    v_mov_b32 v58, v57
    s_nop 1
    v_permlane16_swap_b32 v57, v58
    s_nop 0
    v_add_f32 v57, v57, v58
    v_mov_b32 v58, v57
    s_nop 1
    v_permlane32_swap_b32 v57, v58
    s_nop 0
    v_add_f32 v57, v57, v58
    s_mov_b64 exec, 0x101
    ds_write_b64 v45, v[56:57] offset:3136
    s_mov_b64 exec, 1
    ds_add_u32 v61, v62 offset:3072
    s_mov_b64 exec, -1
    v_cvt_pk_bf16_f32 v40, v40, v40
    v_cvt_pk_bf16_f32 v41, v41, v41
    v_cvt_pk_bf16_f32 v42, v42, v42
    v_cvt_pk_bf16_f32 v43, v43, v43
    v_and_b32 v20, v8, v40
    v_and_b32 v21, v9, v40
    v_and_b32 v22, v10, v40
    v_and_b32 v23, v11, v40
    v_and_b32 v24, v8, v41
    v_and_b32 v25, v9, v41
    v_and_b32 v26, v10, v41
    v_and_b32 v27, v11, v41
    v_and_b32 v28, v8, v42
    v_and_b32 v29, v9, v42
    v_and_b32 v30, v10, v42
    v_and_b32 v31, v11, v42
    v_and_b32 v32, v8, v43
    v_and_b32 v33, v9, v43
    v_and_b32 v34, v10, v43
    v_and_b32 v35, v11, v43
    s_cmp_eq_u32 s64, 0
    s_cbranch_scc1 L_w
L_PV:
    s_branch L_skip4
L_stub3:
    s_branch L_ret2
L_skip4:
    s_add_u32 s28, s28, 2654435761
    s_and_b32 s48, s28, 0xff
    s_bfe_u32 s49, s28, 0x80008
    s_bfe_u32 s50, s28, 0x80010
    s_lshr_b32 s51, s28, 24
    v_mov_b32 v56, s48
    v_mov_b32 v57, s50
    s_mov_b32 exec_lo, 0
    v_mov_b32 v56, s49
    v_mov_b32 v57, s51
    s_mov_b32 exec_lo, -1
    s_waitcnt vmcnt(11)
    v_mfma_f32_16x16x32_bf16 v[48:51], v[20:23], v[96:99], 0
    s_waitcnt vmcnt(10)
    v_mfma_f32_16x16x32_bf16 v[52:55], v[20:23], v[100:103], 0
    s_waitcnt vmcnt(9)
    v_mfma_f32_16x16x32_bf16 v[48:51], v[24:27], v[104:107], v[48:51]
    s_waitcnt vmcnt(8)
    v_mfma_f32_16x16x32_bf16 v[52:55], v[24:27], v[108:111], v[52:55]
    s_waitcnt vmcnt(7)
    v_mfma_f32_16x16x32_bf16 v[48:51], v[28:31], v[112:115], v[48:51]
    s_waitcnt vmcnt(6)
    v_mfma_f32_16x16x32_bf16 v[52:55], v[28:31], v[116:119], v[52:55]
    s_waitcnt vmcnt(5)
    v_mfma_f32_16x16x32_bf16 v[48:51], v[32:35], v[120:123], v[48:51]
    s_waitcnt vmcnt(4)
    v_mfma_f32_16x16x32_bf16 v[52:55], v[32:35], v[124:127], v[52:55]
    s_nop 6
    ds_write_b128 v7, v[48:51] offset:4096
    ds_write_b128 v7, v[52:55] offset:4608
    s_mov_b64 exec, 1
    ds_add_u32 v61, v62 offset:3076
    s_cmp_eq_u32 s31, 0
    s_cbranch_scc1 L_Aexit
L_post:
    s_waitcnt vmcnt(0)
    ds_add_u32 v61, v62 offset:3088
    s_mov_b64 exec, -1
    s_mov_b32 s52, 0x200000
    s_mov_b32 s66, 0x00ff00ff
    s_mov_b32 s67, 16711935
L_avspin:
    ds_read_b128 v[12:15], v46 offset:3328
    s_waitcnt lgkmcnt(0)
    v_max3_u32 v16, v12, v13, v14
    v_and_b32 v20, v8, v12
    v_max_u32 v16, v16, v15
    v_and_b32 v21, v9, v12
    v_cmp_eq_u32 vcc, -1, v16
    v_and_b32 v22, v10, v12
    v_and_b32 v23, v11, v12
    s_cbranch_vccz L_avok
    s_sub_u32 s52, s52, 1
    s_cbranch_scc0 L_avspin
L_avok:
    v_and_b32 v24, v8, v13
    v_and_b32 v25, v9, v13
    v_mfma_f32_16x16x32_bf16 v[48:51], v[20:23], v[128:131], 0
    v_and_b32 v26, v10, v13
    v_and_b32 v27, v11, v13
    v_and_b32 v28, v8, v14
    v_and_b32 v29, v9, v14
    v_mfma_f32_16x16x32_bf16 v[48:51], v[24:27], v[132:135], v[48:51]
    v_and_b32 v30, v10, v14
    v_and_b32 v31, v11, v14
    v_and_b32 v32, v8, v15
    v_and_b32 v33, v9, v15
    v_mfma_f32_16x16x32_bf16 v[48:51], v[28:31], v[136:139], v[48:51]
    v_and_b32 v34, v10, v15
    v_and_b32 v35, v11, v15
    s_nop 1
    v_mfma_f32_16x16x32_bf16 v[48:51], v[32:35], v[140:143], v[48:51]
    s_nop 7
    v_permlane32_swap_b32 v48, v49
    v_permlane32_swap_b32 v50, v51
    s_nop 0
    v_add_f32_dpp v48, v49, v48 row_ror:8 row_mask:0xf bank_mask:0xf
    v_add_f32_dpp v50, v51, v50 row_ror:8 row_mask:0xf bank_mask:0xf
    v_and_or_b32 v49, v48, v60, v56
    v_and_or_b32 v51, v50, v60, v57
    v_and_or_b32 v48, v48, v60, v56
    v_and_or_b32 v50, v50, v60, v57
    s_nop 0
    v_permlane32_swap_b32 v48, v49
    v_permlane32_swap_b32 v50, v51
    s_mov_b64 exec, s[66:67]
    s_nop 0
    buffer_store_dwordx4 v[48:51], v63, s[40:43], s62 offen sc1
L_Aexit:
    s_endpgm
L_stub4:
    s_branch L_ret2
    .p2align 12
L_stub5:
    s_branch L_ret
L_H0b:
    v_lshrrev_b32 v24, 3, v2
    v_mul_u32_u24 v24, 0x0202, v24
    v_add_u32 v24, 0x0100, v24
    v_and_b32 v25, 1, v2
    v_lshlrev_b32 v25, 4, v25
    v_lshlrev_b32 v24, v25, v24
    v_mov_b32 v26, 0x0c0c0000
    v_lshrrev_b32 v26, v25, v26
    v_or_b32 v24, v24, v26
    v_mov_b32 v26, 0x0c0c0c0c
    v_bfe_u32 v25, v2, 1, 2
    v_cmp_eq_u32 vcc, 0, v25
    s_nop 1
    v_cndmask_b32 v20, v26, v24, vcc
    v_cmp_eq_u32 vcc, 1, v25
    s_nop 1
    v_cndmask_b32 v21, v26, v24, vcc
    v_cmp_eq_u32 vcc, 2, v25
    s_nop 1
    v_cndmask_b32 v22, v26, v24, vcc
    v_cmp_eq_u32 vcc, 3, v25
    s_nop 1
    v_cndmask_b32 v23, v26, v24, vcc
    s_mul_i32 s63, s57, 448
    v_mul_u32_u24 v27, 112, v3
    v_add_u32 v27, s63, v27
    v_cmp_gt_u32 s[60:61], 56, v1
    v_lshlrev_b32 v5, 5, v2
    v_and_b32 v6, 1, v3
    v_lshl_add_u32 v5, v6, 4, v5
    v_lshrrev_b32 v6, 1, v3
    v_lshl_add_u32 v5, v6, 3, v5
    s_waitcnt vmcnt(28)
    v_lshlrev_b32 v12, 16, v8
    v_and_b32 v13, 0xffff0000, v8
    v_lshlrev_b32 v14, 16, v9
    v_and_b32 v15, 0xffff0000, v9
    v_lshlrev_b32 v16, 16, v10
    v_and_b32 v17, 0xffff0000, v10
    v_lshlrev_b32 v18, 16, v11
    v_and_b32 v19, 0xffff0000, v11
    v_add_f32 v28, v12, v13
    v_add_f32 v29, v14, v15
    v_add_f32 v30, v16, v17
    v_add_f32 v31, v18, v19
    v_add_f32 v28, v28, v29
    v_add_f32 v30, v30, v31
    v_add_f32 v28, v28, v30
    s_nop 1
    v_add_f32_dpp v28, v28, v28 quad_perm:[1,0,3,2] row_mask:0xf bank_mask:0xf
    s_nop 1
    v_add_f32_dpp v28, v28, v28 quad_perm:[2,3,0,1] row_mask:0xf bank_mask:0xf
    s_nop 1
    v_add_f32_dpp v28, v28, v28 row_half_mirror row_mask:0xf bank_mask:0xf
    s_nop 1
    v_add_f32_dpp v28, v28, v28 row_mirror row_mask:0xf bank_mask:0xf
    v_mov_b32 v29, v28
    s_nop 1
    v_permlane16_swap_b32 v28, v29
    s_nop 0
    v_add_f32 v28, v28, v29
    v_mov_b32 v29, v28
    s_nop 1
    v_permlane32_swap_b32 v28, v29
    s_nop 0
    v_add_f32 v28, v28, v29
    v_mul_f32 v28, 0x3b124925, v28
    v_sub_f32 v32, v12, v28
    v_sub_f32 v33, v13, v28
    v_sub_f32 v34, v14, v28
    v_sub_f32 v35, v15, v28
    v_sub_f32 v36, v16, v28
    v_sub_f32 v37, v17, v28
    v_sub_f32 v38, v18, v28
    v_sub_f32 v39, v19, v28
    v_mul_f32 v30, v32, v32
    v_fmac_f32 v30, v33, v33
    v_fmac_f32 v30, v34, v34
    v_fmac_f32 v30, v35, v35
    v_fmac_f32 v30, v36, v36
    v_fmac_f32 v30, v37, v37
    v_fmac_f32 v30, v38, v38
    v_fmac_f32 v30, v39, v39
    v_cndmask_b32 v30, 0, v30, s[60:61]
    s_nop 1
    v_add_f32_dpp v30, v30, v30 quad_perm:[1,0,3,2] row_mask:0xf bank_mask:0xf
    s_nop 1
    v_add_f32_dpp v30, v30, v30 quad_perm:[2,3,0,1] row_mask:0xf bank_mask:0xf
    s_nop 1
    v_add_f32_dpp v30, v30, v30 row_half_mirror row_mask:0xf bank_mask:0xf
    s_nop 1
    v_add_f32_dpp v30, v30, v30 row_mirror row_mask:0xf bank_mask:0xf
    v_mov_b32 v29, v30
    s_nop 1
    v_permlane16_swap_b32 v30, v29
    s_nop 0
    v_add_f32 v30, v30, v29
    v_mov_b32 v29, v30
    s_nop 1
    v_permlane32_swap_b32 v30, v29
    s_nop 0
    v_add_f32 v30, v30, v29
    v_mul_f32 v30, 0x3b124925, v30
    v_cvt_pk_bf16_f32 v30, v30, v30
    v_lshlrev_b32 v30, 16, v30
    v_add_f32 v30, 0x3727c5ac, v30
    v_cvt_pk_bf16_f32 v30, v30, v30
    v_lshlrev_b32 v30, 16, v30
    v_sqrt_f32 v30, v30
    s_nop 0
    v_cvt_pk_bf16_f32 v30, v30, v30
    v_lshlrev_b32 v30, 16, v30
    v_rcp_f32 v30, v30
    v_cvt_pk_bf16_f32 v28, v28, v28
    v_lshlrev_b32 v28, 16, v28
    v_sub_f32 v32, v12, v28
    v_sub_f32 v33, v13, v28
    v_sub_f32 v34, v14, v28
    v_sub_f32 v35, v15, v28
    v_sub_f32 v36, v16, v28
    v_sub_f32 v37, v17, v28
    v_sub_f32 v38, v18, v28
    v_sub_f32 v39, v19, v28
    v_cvt_pk_bf16_f32 v8, v32, v33
    v_cvt_pk_bf16_f32 v9, v34, v35
    v_cvt_pk_bf16_f32 v10, v36, v37
    v_cvt_pk_bf16_f32 v11, v38, v39
    v_lshlrev_b32 v32, 16, v8
    v_and_b32 v33, 0xffff0000, v8
    v_lshlrev_b32 v34, 16, v9
    v_and_b32 v35, 0xffff0000, v9
    v_lshlrev_b32 v36, 16, v10
    v_and_b32 v37, 0xffff0000, v10
    v_lshlrev_b32 v38, 16, v11
    v_and_b32 v39, 0xffff0000, v11
    v_mul_f32 v32, v32, v30
    v_mul_f32 v33, v33, v30
    v_mul_f32 v34, v34, v30
    v_mul_f32 v35, v35, v30
    v_mul_f32 v36, v36, v30
    v_mul_f32 v37, v37, v30
    v_mul_f32 v38, v38, v30
    v_mul_f32 v39, v39, v30
    v_cvt_pk_bf16_f32 v8, v32, v33
    v_cvt_pk_bf16_f32 v9, v34, v35
    v_cvt_pk_bf16_f32 v10, v36, v37
    v_cvt_pk_bf16_f32 v11, v38, v39
    ds_write_b128 v7, v[8:11]
    v_mov_b32 v4, v27
    ds_read_b128 v[28:31], v4 offset:0
    ds_read_b128 v[32:35], v4 offset:16
    ds_read_b128 v[36:39], v4 offset:32
    ds_read_b128 v[40:43], v4 offset:48
    ds_read_b128 v[44:47], v4 offset:64
    ds_read_b128 v[8:11], v4 offset:80
    ds_read_b128 v[24:27], v4 offset:96
    s_waitcnt lgkmcnt(0)
    s_branch L_skip6
L_stub6:
    s_branch L_ret
L_skip6:
    s_add_u32 s28, s28, 2654435761
    s_and_b32 s48, s28, 0xff
    s_bfe_u32 s49, s28, 0x80008
    s_bfe_u32 s50, s28, 0x80010
    s_lshr_b32 s51, s28, 24
    v_mov_b32 v18, s48
    v_mov_b32 v19, s49
    s_mov_b32 exec_lo, 0
    v_mov_b32 v18, s50
    v_mov_b32 v19, s51
    s_mov_b32 exec_lo, -1
    v_perm_b32 v48, v28, v28, v20
    v_perm_b32 v49, v28, v28, v21
    v_perm_b32 v50, v28, v28, v22
    v_perm_b32 v51, v28, v28, v23
    s_waitcnt vmcnt(27)
    s_nop 0
    v_mfma_f32_16x16x32_bf16 v[12:15], v[48:51], v[56:59], 0
    v_perm_b32 v52, v29, v29, v20
    v_perm_b32 v53, v29, v29, v21
    v_perm_b32 v54, v29, v29, v22
    v_perm_b32 v55, v29, v29, v23
    s_waitcnt vmcnt(26)
    s_nop 0
    v_mfma_f32_16x16x32_bf16 v[12:15], v[52:55], v[60:63], v[12:15]
    v_perm_b32 v48, v30, v30, v20
    v_perm_b32 v49, v30, v30, v21
    v_perm_b32 v50, v30, v30, v22
    v_perm_b32 v51, v30, v30, v23
    s_waitcnt vmcnt(25)
    s_nop 0
    v_mfma_f32_16x16x32_bf16 v[12:15], v[48:51], v[64:67], v[12:15]
    v_perm_b32 v52, v31, v31, v20
    v_perm_b32 v53, v31, v31, v21
    v_perm_b32 v54, v31, v31, v22
    v_perm_b32 v55, v31, v31, v23
    s_waitcnt vmcnt(24)
    s_nop 0
    v_mfma_f32_16x16x32_bf16 v[12:15], v[52:55], v[68:71], v[12:15]
    v_perm_b32 v48, v32, v32, v20
    v_perm_b32 v49, v32, v32, v21
    v_perm_b32 v50, v32, v32, v22
    v_perm_b32 v51, v32, v32, v23
    s_waitcnt vmcnt(23)
    s_nop 0
    v_mfma_f32_16x16x32_bf16 v[12:15], v[48:51], v[72:75], v[12:15]
    v_perm_b32 v52, v33, v33, v20
    v_perm_b32 v53, v33, v33, v21
    v_perm_b32 v54, v33, v33, v22
    v_perm_b32 v55, v33, v33, v23
    s_waitcnt vmcnt(22)
    s_nop 0
    v_mfma_f32_16x16x32_bf16 v[12:15], v[52:55], v[76:79], v[12:15]
    v_perm_b32 v48, v34, v34, v20
    v_perm_b32 v49, v34, v34, v21
    v_perm_b32 v50, v34, v34, v22
    v_perm_b32 v51, v34, v34, v23
    s_waitcnt vmcnt(21)
    s_nop 0
    v_mfma_f32_16x16x32_bf16 v[12:15], v[48:51], v[80:83], v[12:15]
    v_perm_b32 v52, v35, v35, v20
    v_perm_b32 v53, v35, v35, v21
    v_perm_b32 v54, v35, v35, v22
    v_perm_b32 v55, v35, v35, v23
    s_waitcnt vmcnt(20)
    s_nop 0
    v_mfma_f32_16x16x32_bf16 v[12:15], v[52:55], v[84:87], v[12:15]
    v_perm_b32 v48, v36, v36, v20
    v_perm_b32 v49, v36, v36, v21
    v_perm_b32 v50, v36, v36, v22
    v_perm_b32 v51, v36, v36, v23
    s_waitcnt vmcnt(19)
    s_nop 0
    v_mfma_f32_16x16x32_bf16 v[12:15], v[48:51], v[88:91], v[12:15]
    v_perm_b32 v52, v37, v37, v20
    v_perm_b32 v53, v37, v37, v21
    v_perm_b32 v54, v37, v37, v22
    v_perm_b32 v55, v37, v37, v23
    s_waitcnt vmcnt(18)
    s_nop 0
    v_mfma_f32_16x16x32_bf16 v[12:15], v[52:55], v[92:95], v[12:15]
    s_branch L_skip7
L_stub7:
    s_branch L_ret
L_skip7:
    v_perm_b32 v48, v38, v38, v20
    v_perm_b32 v49, v38, v38, v21
    v_perm_b32 v50, v38, v38, v22
    v_perm_b32 v51, v38, v38, v23
    s_waitcnt vmcnt(17)
    s_nop 0
    v_mfma_f32_16x16x32_bf16 v[12:15], v[48:51], v[96:99], v[12:15]
    v_perm_b32 v52, v39, v39, v20
    v_perm_b32 v53, v39, v39, v21
    v_perm_b32 v54, v39, v39, v22
    v_perm_b32 v55, v39, v39, v23
    s_waitcnt vmcnt(16)
    s_nop 0
    v_mfma_f32_16x16x32_bf16 v[12:15], v[52:55], v[100:103], v[12:15]
    v_perm_b32 v48, v40, v40, v20
    v_perm_b32 v49, v40, v40, v21
    v_perm_b32 v50, v40, v40, v22
    v_perm_b32 v51, v40, v40, v23
    s_waitcnt vmcnt(15)
    s_nop 0
    v_mfma_f32_16x16x32_bf16 v[12:15], v[48:51], v[104:107], v[12:15]
    v_perm_b32 v52, v41, v41, v20
    v_perm_b32 v53, v41, v41, v21
    v_perm_b32 v54, v41, v41, v22
    v_perm_b32 v55, v41, v41, v23
    s_waitcnt vmcnt(14)
    s_nop 0
    v_mfma_f32_16x16x32_bf16 v[12:15], v[52:55], v[108:111], v[12:15]
    v_perm_b32 v48, v42, v42, v20
    v_perm_b32 v49, v42, v42, v21
    v_perm_b32 v50, v42, v42, v22
    v_perm_b32 v51, v42, v42, v23
    s_waitcnt vmcnt(13)
    s_nop 0
    v_mfma_f32_16x16x32_bf16 v[12:15], v[48:51], v[112:115], v[12:15]
    v_perm_b32 v52, v43, v43, v20
    v_perm_b32 v53, v43, v43, v21
    v_perm_b32 v54, v43, v43, v22
    v_perm_b32 v55, v43, v43, v23
    s_waitcnt vmcnt(12)
    s_nop 0
    v_mfma_f32_16x16x32_bf16 v[12:15], v[52:55], v[116:119], v[12:15]
    v_perm_b32 v48, v44, v44, v20
    v_perm_b32 v49, v44, v44, v21
    v_perm_b32 v50, v44, v44, v22
    v_perm_b32 v51, v44, v44, v23
    s_waitcnt vmcnt(11)
    s_nop 0
    v_mfma_f32_16x16x32_bf16 v[12:15], v[48:51], v[120:123], v[12:15]
    v_perm_b32 v52, v45, v45, v20
    v_perm_b32 v53, v45, v45, v21
    v_perm_b32 v54, v45, v45, v22
    v_perm_b32 v55, v45, v45, v23
    s_waitcnt vmcnt(10)
    s_nop 0
    v_mfma_f32_16x16x32_bf16 v[12:15], v[52:55], v[124:127], v[12:15]
    v_perm_b32 v48, v46, v46, v20
    v_perm_b32 v49, v46, v46, v21
    v_perm_b32 v50, v46, v46, v22
    v_perm_b32 v51, v46, v46, v23
    s_waitcnt vmcnt(9)
    s_nop 0
    v_mfma_f32_16x16x32_bf16 v[12:15], v[48:51], v[128:131], v[12:15]
    v_perm_b32 v52, v47, v47, v20
    v_perm_b32 v53, v47, v47, v21
    v_perm_b32 v54, v47, v47, v22
    v_perm_b32 v55, v47, v47, v23
    s_waitcnt vmcnt(8)
    s_nop 0
    v_mfma_f32_16x16x32_bf16 v[12:15], v[52:55], v[132:135], v[12:15]
    s_branch L_skip8
L_stub8:
    s_branch L_ret
L_skip8:
    v_perm_b32 v48, v8, v8, v20
    v_perm_b32 v49, v8, v8, v21
    v_perm_b32 v50, v8, v8, v22
    v_perm_b32 v51, v8, v8, v23
    s_waitcnt vmcnt(7)
    s_nop 0
    v_mfma_f32_16x16x32_bf16 v[12:15], v[48:51], v[136:139], v[12:15]
    v_perm_b32 v52, v9, v9, v20
    v_perm_b32 v53, v9, v9, v21
    v_perm_b32 v54, v9, v9, v22
    v_perm_b32 v55, v9, v9, v23
    s_waitcnt vmcnt(6)
    s_nop 0
    v_mfma_f32_16x16x32_bf16 v[12:15], v[52:55], v[140:143], v[12:15]
    v_perm_b32 v48, v10, v10, v20
    v_perm_b32 v49, v10, v10, v21
    v_perm_b32 v50, v10, v10, v22
    v_perm_b32 v51, v10, v10, v23
    s_waitcnt vmcnt(5)
    s_nop 0
    v_mfma_f32_16x16x32_bf16 v[12:15], v[48:51], v[144:147], v[12:15]
    v_perm_b32 v52, v11, v11, v20
    v_perm_b32 v53, v11, v11, v21
    v_perm_b32 v54, v11, v11, v22
    v_perm_b32 v55, v11, v11, v23
    s_waitcnt vmcnt(4)
    s_nop 0
    v_mfma_f32_16x16x32_bf16 v[12:15], v[52:55], v[148:151], v[12:15]
    v_perm_b32 v48, v24, v24, v20
    v_perm_b32 v49, v24, v24, v21
    v_perm_b32 v50, v24, v24, v22
    v_perm_b32 v51, v24, v24, v23
    s_waitcnt vmcnt(3)
    s_nop 0
    v_mfma_f32_16x16x32_bf16 v[12:15], v[48:51], v[152:155], v[12:15]
    v_perm_b32 v52, v25, v25, v20
    v_perm_b32 v53, v25, v25, v21
    v_perm_b32 v54, v25, v25, v22
    v_perm_b32 v55, v25, v25, v23
    s_waitcnt vmcnt(2)
    s_nop 0
    v_mfma_f32_16x16x32_bf16 v[12:15], v[52:55], v[156:159], v[12:15]
    v_perm_b32 v48, v26, v26, v20
    v_perm_b32 v49, v26, v26, v21
    v_perm_b32 v50, v26, v26, v22
    v_perm_b32 v51, v26, v26, v23
    s_waitcnt vmcnt(1)
    s_nop 0
    v_mfma_f32_16x16x32_bf16 v[12:15], v[48:51], v[160:163], v[12:15]
    v_perm_b32 v52, v27, v27, v20
    v_perm_b32 v53, v27, v27, v21
    v_perm_b32 v54, v27, v27, v22
    v_perm_b32 v55, v27, v27, v23
    s_waitcnt vmcnt(0)
    s_nop 0
    v_mfma_f32_16x16x32_bf16 v[12:15], v[52:55], v[164:167], v[12:15]
    s_mov_b32 s66, 0x00ff00ff
    s_mov_b32 s67, 0x00ff00ff
    s_add_u32 s78, s62, -2359296
    v_mov_b32 v60, 0xffffff00
    v_mov_b32 v61, 0
    v_mov_b32 v62, 1
    s_cmp_lt_u32 s79, 16
    s_cselect_b32 s76, 1, 0
    v_permlane32_swap_b32 v12, v13
    v_permlane32_swap_b32 v14, v15
    s_nop 0
    v_add_f32_dpp v12, v13, v12 row_ror:8 row_mask:0xf bank_mask:0xf
    v_add_f32_dpp v14, v15, v14 row_ror:8 row_mask:0xf bank_mask:0xf
    v_and_or_b32 v12, v12, v60, v18
    v_and_or_b32 v13, v14, v60, v19
    s_mov_b64 exec, s[66:67]
    s_cbranch_scc0 L_gpst
    buffer_store_dwordx2 v[12:13], v5, s[40:43], s78 offen
    s_lshl_b32 s63, s29, 15
    s_lshl_b32 s64, s79, 2
    s_add_u32 s63, s63, s64
    s_add_u32 s63, s63, 1835008
    s_mov_b64 exec, -1
    v_mov_b32 v16, s28
    v_lshlrev_b32 v17, 6, v1
    s_mov_b32 exec_hi, 0
    buffer_store_dword v16, v17, s[40:43], s63 offen
    s_branch L_gpst2
L_gpst:
    s_cmp_ge_u32 s79, 30
    s_cbranch_scc1 L_gpst2
    buffer_store_dwordx2 v[12:13], v5, s[40:43], s62 offen sc1
L_gpst2:
    s_mov_b64 exec, 1
    ds_write_b32 v61, v62 offset:3092
    s_mov_b64 exec, -1
    s_mov_b32 s52, 0x200000
L_colo0:
    ds_read_b32 v26, v61 offset:3100
    s_waitcnt lgkmcnt(0)
    v_readfirstlane_b32 s77, v26
    s_cmp_lg_u32 s77, 0
    s_cbranch_scc1 L_colo0k
    s_sleep 4
    s_sub_u32 s52, s52, 1
    s_cbranch_scc0 L_colo0
L_colo0k:
    s_cmp_eq_u32 s77, 1
    s_cbranch_scc1 L_stats
    s_cmp_eq_u32 s76, 0
    s_cbranch_scc1 L_stats
    s_mov_b64 exec, s[66:67]
    buffer_store_dwordx2 v[12:13], v5, s[40:43], s62 offen sc1
    s_mov_b64 exec, -1
    s_branch L_stats
L_H1:
    s_lshl_b32 s62, s29, 12
    s_add_u32 s62, s62, 2363392
    s_lshl_b32 s63, s3, 9
    v_lshlrev_b32 v5, 3, v1
    v_mov_b32 v6, 16
    s_sleep 40
    s_lshl_b32 s64, s29, 15
    s_add_u32 s64, s64, 1835008
    s_mov_b32 s70, s28
    s_mov_b32 s71, s28
    s_mov_b32 s52, 31
L_sf:
    s_load_dwordx16 s[4:19], s[26:27], s64
    s_add_u32 s64, s64, 64
    ds_read_b32 v24, v61 offset:3100
    s_waitcnt lgkmcnt(0)
    s_xor_b64 s[4:5], s[4:5], s[70:71]
    s_xor_b64 s[6:7], s[6:7], s[70:71]
    s_xor_b64 s[8:9], s[8:9], s[70:71]
    s_xor_b64 s[10:11], s[10:11], s[70:71]
    s_xor_b64 s[12:13], s[12:13], s[70:71]
    s_xor_b64 s[14:15], s[14:15], s[70:71]
    s_xor_b64 s[16:17], s[16:17], s[70:71]
    s_xor_b64 s[18:19], s[18:19], s[70:71]
    s_or_b64 s[4:5], s[4:5], s[6:7]
    s_or_b64 s[4:5], s[4:5], s[8:9]
    s_or_b64 s[4:5], s[4:5], s[10:11]
    s_or_b64 s[4:5], s[4:5], s[12:13]
    s_or_b64 s[4:5], s[4:5], s[14:15]
    s_or_b64 s[4:5], s[4:5], s[16:17]
    s_or_b64 s[4:5], s[4:5], s[18:19]
    s_cbranch_scc0 L_sfok
    v_readfirstlane_b32 s77, v24
    s_cmp_eq_u32 s77, 2
    s_cbranch_scc1 L_sfok
    s_sub_u32 s52, s52, 1
    s_cbranch_scc0 L_sf
L_sfok:
    s_mov_b32 s52, 20000
    s_cmp_eq_u32 s77, 2
    s_cselect_b32 s53, 0, -2359296
    s_add_u32 s62, s62, s53
    buffer_load_dwordx4 v[64:67], v7, s[40:43], s62 offen offset:0 sc1
    buffer_load_dwordx4 v[68:71], v7, s[40:43], s62 offen offset:1024 sc1
    buffer_load_dwordx4 v[72:75], v7, s[40:43], s62 offen offset:2048 sc1
    buffer_load_dwordx4 v[76:79], v7, s[40:43], s62 offen offset:3072 sc1
    s_sleep 5
L_pl2:
    buffer_load_dwordx4 v[80:83], v7, s[40:43], s62 offen offset:0 sc1
    buffer_load_dwordx4 v[84:87], v7, s[40:43], s62 offen offset:1024 sc1
    buffer_load_dwordx4 v[88:91], v7, s[40:43], s62 offen offset:2048 sc1
    buffer_load_dwordx4 v[92:95], v7, s[40:43], s62 offen offset:3072 sc1
    ds_or_b32 v61, v6 offset:3080
    s_branch L_skip11
L_stub9:
    s_branch L_ret
L_skip11:
    s_waitcnt vmcnt(7)
    v_xor_b32 v32, s48, v64
    v_xor_b32 v33, s49, v65
    v_xor_b32 v34, s50, v66
    v_xor_b32 v35, s51, v67
    v_or3_b32 v24, v32, v33, v34
    v_or_b32 v24, v24, v35
    s_waitcnt vmcnt(6)
    v_xor_b32 v36, s48, v68
    v_xor_b32 v37, s49, v69
    v_xor_b32 v38, s50, v70
    v_xor_b32 v39, s51, v71
    v_or3_b32 v24, v24, v36, v37
    v_or3_b32 v24, v24, v38, v39
    s_waitcnt vmcnt(5)
    v_xor_b32 v40, s48, v72
    v_xor_b32 v41, s49, v73
    v_xor_b32 v42, s50, v74
    v_xor_b32 v43, s51, v75
    v_or3_b32 v24, v24, v40, v41
    v_or3_b32 v24, v24, v42, v43
    s_waitcnt vmcnt(4)
    v_xor_b32 v44, s48, v76
    v_xor_b32 v45, s49, v77
    v_xor_b32 v46, s50, v78
    v_xor_b32 v47, s51, v79
    v_or3_b32 v24, v24, v44, v45
    v_or3_b32 v24, v24, v46, v47
    v_cmp_ne_u32_sdwa vcc, v24, v61 src0_sel:BYTE_0 src1_sel:DWORD
    s_cbranch_vccz L_ok2
    buffer_load_dwordx4 v[64:67], v7, s[40:43], s62 offen offset:0 sc1
    buffer_load_dwordx4 v[68:71], v7, s[40:43], s62 offen offset:1024 sc1
    buffer_load_dwordx4 v[72:75], v7, s[40:43], s62 offen offset:2048 sc1
    buffer_load_dwordx4 v[76:79], v7, s[40:43], s62 offen offset:3072 sc1
    s_waitcnt vmcnt(7)
    v_xor_b32 v32, s48, v80
    v_xor_b32 v33, s49, v81
    v_xor_b32 v34, s50, v82
    v_xor_b32 v35, s51, v83
    v_or3_b32 v24, v32, v33, v34
    v_or_b32 v24, v24, v35
    s_waitcnt vmcnt(6)
    v_xor_b32 v36, s48, v84
    v_xor_b32 v37, s49, v85
    v_xor_b32 v38, s50, v86
    v_xor_b32 v39, s51, v87
    v_or3_b32 v24, v24, v36, v37
    v_or3_b32 v24, v24, v38, v39
    s_waitcnt vmcnt(5)
    v_xor_b32 v40, s48, v88
    v_xor_b32 v41, s49, v89
    v_xor_b32 v42, s50, v90
    v_xor_b32 v43, s51, v91
    v_or3_b32 v24, v24, v40, v41
    v_or3_b32 v24, v24, v42, v43
    s_waitcnt vmcnt(4)
    v_xor_b32 v44, s48, v92
    v_xor_b32 v45, s49, v93
    v_xor_b32 v46, s50, v94
    v_xor_b32 v47, s51, v95
    v_or3_b32 v24, v24, v44, v45
    v_or3_b32 v24, v24, v46, v47
    v_cmp_ne_u32_sdwa vcc, v24, v61 src0_sel:BYTE_0 src1_sel:DWORD
    s_cbranch_vccz L_ok2
    s_cmp_lg_u32 s77, 0
    s_cbranch_scc1 L_pc2
    ds_read_b32 v24, v61 offset:3100
    s_waitcnt lgkmcnt(0)
    v_readfirstlane_b32 s77, v24
    s_cmp_eq_u32 s77, 2
    s_cbranch_scc0 L_pc2
    s_sub_u32 s62, s62, -2359296
L_pc2:
    s_sub_u32 s52, s52, 1
    s_cbranch_scc0 L_pl2
L_ok2:
    v_pk_add_f32 v[32:33], v[32:33], v[40:41]
    v_pk_add_f32 v[34:35], v[34:35], v[42:43]
    v_pk_add_f32 v[36:37], v[36:37], v[44:45]
    v_pk_add_f32 v[38:39], v[38:39], v[46:47]
    v_cvt_pk_bf16_f32 v32, v32, v34
    v_cvt_pk_bf16_f32 v33, v33, v35
    v_cvt_pk_bf16_f32 v36, v36, v38
    v_cvt_pk_bf16_f32 v37, v37, v39
    ds_write_b64 v5, v[32:33] offset:2048
    ds_write_b64 v5, v[36:37] offset:2560
    s_mov_b64 exec, 1
    ds_add_u32 v61, v62 offset:3080
    s_mov_b64 exec, -1
    s_mov_b32 s52, 0x200000
L_colo1:
    ds_read_b32 v26, v61 offset:3100
    s_waitcnt lgkmcnt(0)
    v_readfirstlane_b32 s77, v26
    s_cmp_lg_u32 s77, 0
    s_cbranch_scc1 L_stats
    s_sleep 4
    s_sub_u32 s52, s52, 1
    s_cbranch_scc0 L_colo1
L_stats:
    v_and_b32 v25, 7, v1
    v_lshlrev_b32 v25, 4, v25
    s_lshl_b32 s63, s3, 3
    v_add_u32 v25, s63, v25
    s_cmp_eq_u32 s77, 1
    s_cselect_b32 s74, -2359296, 0
    s_lshl_b32 s62, s29, 10
    s_lshl_b32 s63, s3, 9
    s_add_u32 s62, s62, s63
    s_lshl_b32 s63, s30, 4
    s_add_u32 s62, s62, s63
    s_add_u32 s75, s62, 2400256
    s_add_u32 s75, s75, s74
    s_mov_b32 s52, 2097152
L_spin3:
    ds_read_b32 v26, v61 offset:3072
    s_waitcnt lgkmcnt(0)
    v_readfirstlane_b32 s53, v26
    s_cmp_eq_u32 s53, 8
    s_cbranch_scc1 L_sok3
    s_sleep 1
    s_sub_u32 s52, s52, 1
    s_cbranch_scc0 L_spin3
L_sok3:
    ds_read_b64 v[26:27], v25 offset:3136
    s_waitcnt lgkmcnt(0)
    v_mov_b32 v28, v26
    s_nop 1
    v_max_f32_dpp v28, v28, v28 quad_perm:[1,0,3,2] row_mask:0xf bank_mask:0xf
    s_nop 1
    v_max_f32_dpp v28, v28, v28 quad_perm:[2,3,0,1] row_mask:0xf bank_mask:0xf
    s_nop 1
    v_max_f32_dpp v28, v28, v28 row_half_mirror row_mask:0xf bank_mask:0xf
    v_sub_f32 v26, v26, v28
    v_mul_f32 v26, s55, v26
    v_exp_f32 v26, v26
    s_nop 0
    v_mul_f32 v29, v26, v27
    s_nop 1
    v_add_f32_dpp v29, v29, v29 quad_perm:[1,0,3,2] row_mask:0xf bank_mask:0xf
    s_nop 1
    v_add_f32_dpp v29, v29, v29 quad_perm:[2,3,0,1] row_mask:0xf bank_mask:0xf
    s_nop 1
    v_add_f32_dpp v29, v29, v29 row_half_mirror row_mask:0xf bank_mask:0xf
    v_readlane_b32 s56, v26, 0
    v_readlane_b32 s58, v26, 1
    v_readlane_b32 s60, v26, 2
    v_readlane_b32 s68, v26, 3
    v_readlane_b32 s70, v26, 4
    v_readlane_b32 s72, v26, 5
    v_readlane_b32 s96, v26, 6
    v_readlane_b32 s98, v26, 7
    v_and_or_b32 v8, v28, v60, s48
    v_and_or_b32 v9, v29, v60, s49
    v_and_or_b32 v10, v61, v60, s50
    v_and_or_b32 v11, v61, v60, s51
    s_mov_b64 exec, 1
    s_cmp_eq_u32 s74, 0
    s_cbranch_scc1 L_mls
    buffer_store_dwordx4 v[8:11], v61, s[40:43], s75 offen
    s_branch L_mll
L_mls:
    buffer_store_dwordx4 v[8:11], v61, s[40:43], s75 offen sc1
L_mll:
    s_mov_b64 exec, -1
    v_lshrrev_b32 v25, 3, v1
    v_lshlrev_b32 v25, 12, v25
    v_and_b32 v26, 7, v1
    v_lshl_add_u32 v25, v26, 4, v25
    s_lshl_b32 s62, s29, 16
    s_lshl_b32 s63, s3, 15
    s_add_u32 s62, s62, s63
    s_lshl_b32 s63, s30, 7
    s_add_u32 s62, s62, s63
    s_add_u32 s73, s62, 2523136
    s_add_u32 s73, s73, s74
    s_lshl_b32 s63, s3, 10
    v_lshl_add_u32 v27, v1, 4, s63
    s_branch L_skip14
L_stub10:
    s_branch L_ret
    .p2align 12
L_stub11:
    s_branch L_ret
L_skip14:
    s_mov_b32 s52, 0x200000
L_c4a:
    ds_read_b32 v26, v61 offset:3076
    s_waitcnt lgkmcnt(0)
    v_readfirstlane_b32 s53, v26
    s_cmp_ge_u32 s53, 6
    s_cbranch_scc1 L_c4b
    s_sub_u32 s52, s52, 1
    s_cbranch_scc0 L_c4a
L_c4b:
    ds_read_b32 v26, v61 offset:3076
    ds_read_b128 v[28:31], v27 offset:4096
    ds_read_b128 v[32:35], v27 offset:6144
    ds_read_b128 v[36:39], v27 offset:8192
    ds_read_b128 v[40:43], v27 offset:10240
    ds_read_b128 v[44:47], v27 offset:12288
    ds_read_b128 v[48:51], v27 offset:14336
    ds_read_b128 v[52:55], v27 offset:16384
    ds_read_b128 v[56:59], v27 offset:18432
    s_waitcnt lgkmcnt(8)
    v_readfirstlane_b32 s53, v26
    s_cmp_eq_u32 s53, 8
    s_cbranch_scc1 L_c4ok
    s_waitcnt lgkmcnt(0)
    s_sub_u32 s52, s52, 1
    s_cbranch_scc0 L_c4b
L_c4ok:
    s_waitcnt lgkmcnt(7)
    v_pk_mul_f32 v[12:13], v[28:29], s[56:57] op_sel_hi:[1,0]
    v_pk_mul_f32 v[14:15], v[30:31], s[56:57] op_sel_hi:[1,0]
    s_waitcnt lgkmcnt(6)
    v_pk_fma_f32 v[12:13], v[32:33], s[58:59], v[12:13] op_sel_hi:[1,0,1]
    v_pk_fma_f32 v[14:15], v[34:35], s[58:59], v[14:15] op_sel_hi:[1,0,1]
    s_waitcnt lgkmcnt(5)
    v_pk_fma_f32 v[12:13], v[36:37], s[60:61], v[12:13] op_sel_hi:[1,0,1]
    v_pk_fma_f32 v[14:15], v[38:39], s[60:61], v[14:15] op_sel_hi:[1,0,1]
    s_waitcnt lgkmcnt(4)
    v_pk_fma_f32 v[12:13], v[40:41], s[68:69], v[12:13] op_sel_hi:[1,0,1]
    v_pk_fma_f32 v[14:15], v[42:43], s[68:69], v[14:15] op_sel_hi:[1,0,1]
    s_waitcnt lgkmcnt(3)
    v_pk_fma_f32 v[12:13], v[44:45], s[70:71], v[12:13] op_sel_hi:[1,0,1]
    v_pk_fma_f32 v[14:15], v[46:47], s[70:71], v[14:15] op_sel_hi:[1,0,1]
    s_waitcnt lgkmcnt(2)
    v_pk_fma_f32 v[12:13], v[48:49], s[72:73], v[12:13] op_sel_hi:[1,0,1]
    v_pk_fma_f32 v[14:15], v[50:51], s[72:73], v[14:15] op_sel_hi:[1,0,1]
    s_waitcnt lgkmcnt(1)
    v_pk_fma_f32 v[12:13], v[52:53], s[96:97], v[12:13] op_sel_hi:[1,0,1]
    v_pk_fma_f32 v[14:15], v[54:55], s[96:97], v[14:15] op_sel_hi:[1,0,1]
    s_waitcnt lgkmcnt(0)
    v_pk_fma_f32 v[12:13], v[56:57], s[98:99], v[12:13] op_sel_hi:[1,0,1]
    v_pk_fma_f32 v[14:15], v[58:59], s[98:99], v[14:15] op_sel_hi:[1,0,1]
    s_cmp_eq_u32 s74, 0
    v_and_or_b32 v16, v12, v60, s48
    v_and_or_b32 v17, v13, v60, s49
    v_and_or_b32 v18, v14, v60, s50
    v_and_or_b32 v19, v15, v60, s51
    s_cbranch_scc1 L_pts
    buffer_store_dwordx4 v[16:19], v25, s[40:43], s73 offen
    s_mov_b64 exec, 1
    ds_add_u32 v61, v62 offset:3096
    s_branch L_exit
L_pts:
    buffer_store_dwordx4 v[16:19], v25, s[40:43], s73 offen sc1
    s_mov_b64 exec, 1
    ds_add_u32 v61, v62 offset:3096
    s_branch L_exit
L_H123:
    s_setprio 3
    s_mov_b32 s77, 0
    s_mov_b32 s38, 896
    v_lshlrev_b32 v7, 2, v1
    v_mov_b32 v8, -1
    s_cmp_eq_u32 s3, 3
    s_cbranch_scc1 L_i3
    ds_write_b32 v7, v61 offset:3072
    ds_write_b32 v7, v61 offset:3584
    s_branch L_i4
L_i3:
    ds_write_b32 v7, v8 offset:3328
L_i4:
    s_waitcnt lgkmcnt(0)
    s_mov_b32 s40, s26
    s_mov_b32 s41, s27
    s_load_dword s28, s[26:27], 0
    s_barrier
    v_lshlrev_b32 v7, 4, v1
    s_lshl_b32 s62, s29, 4
    s_add_u32 s62, s62, s30
    s_lshl_b32 s62, s62, 12
    s_add_u32 s62, s62, 2523136
    s_cmp_eq_u32 s3, 3
    s_cbranch_scc0 L_n3
    s_lshl_b32 s63, s29, 5
    s_add_u32 s63, s63, s30
    s_lshl_b32 s63, s63, 7
    s_add_u32 s63, s63, 131072
    s_lshl_b32 s64, s29, 12
    s_lshl_b32 s65, s30, 7
    s_add_u32 s64, s64, s65
    s_add_u32 s64, s64, 4096
    s_add_u32 s65, s63, -2359296
    s_lshl_b32 s65, s29, 10
    s_lshl_b32 s67, s30, 5
    s_add_u32 s65, s65, s67
    s_add_u32 s65, s65, 40960
    s_mov_b64 exec, 0xff
    buffer_load_dwordx4 v[128:131], v7, s[40:43], s64 offen sc1
    s_lshl_b32 s64, s29, 15
    s_lshl_b32 s67, s30, 7
    s_add_u32 s64, s64, s67
    s_add_u32 s64, s64, 1835008
    buffer_load_dwordx4 v[136:139], v7, s[40:43], s64 offen sc1
    s_mov_b64 exec, 1
    buffer_load_dwordx4 v[132:135], v7, s[40:43], s65 offen sc1
    s_mov_b64 exec, -1
    s_getreg_b32 s66, hwreg(HW_REG_XCC_ID)
    s_lshl_b32 s66, s66, 8
    v_mov_b32 v12, s66
    s_waitcnt lgkmcnt(0)
    s_add_u32 s28, s28, 2654435761
    s_and_b32 s48, s28, 0xff
    s_bfe_u32 s49, s28, 0x80008
    s_bfe_u32 s50, s28, 0x80010
    s_lshr_b32 s51, s28, 24
    v_and_or_b32 v8, v12, v60, s48
    v_and_or_b32 v9, v61, v60, s49
    v_and_or_b32 v10, v61, v60, s50
    v_and_or_b32 v11, v61, v60, s51
    s_mov_b64 exec, 1
    buffer_store_dwordx4 v[8:11], v61, s[40:43], s63 offen offset:64 sc1
    ds_add_u32 v61, v62 offset:3080
    s_mov_b64 exec, -1
    s_lshl_b32 s63, s29, 12
    s_add_u32 s63, s63, 131136
    v_and_b32 v26, 31, v1
    v_lshlrev_b32 v26, 7, v26
    s_sleep 60
    s_mov_b32 s52, 20000
L_pl4:
    buffer_load_dwordx4 v[64:67], v26, s[40:43], s63 offen sc1
    s_waitcnt vmcnt(0)
    v_xor_b32 v8, s48, v64
    v_xor_b32 v9, s49, v65
    v_xor_b32 v10, s50, v66
    v_xor_b32 v11, s51, v67
    v_or3_b32 v24, v8, v9, v10
    v_or_b32 v24, v24, v11
    v_cmp_ne_u32_sdwa vcc, v24, v61 src0_sel:BYTE_0 src1_sel:DWORD
    s_cbranch_vccz L_ok4
    s_sleep 8
    s_sub_u32 s52, s52, 1
    s_cbranch_scc0 L_pl4
L_ok4:
    v_cmp_ne_u32 vcc, s66, v8
    s_mov_b32 s77, 1
    s_cbranch_vccz L_xok
    s_mov_b32 s77, 2
L_xok:
    v_mov_b32 v24, s77
    s_mov_b64 exec, 1
    ds_write_b32 v61, v24 offset:3100
    s_mov_b64 exec, -1
    s_branch L_role
L_stub12:
    s_branch L_ret
L_n3:
    s_cmp_eq_u32 s3, 2
    s_cbranch_scc0 L_npo
    s_cmp_lt_u32 s30, 16
    s_cbranch_scc0 L_npo
    s_add_u32 s63, s62, -2359296
    buffer_load_dwordx4 v[128:131], v7, s[40:43], s63 offen offset:0 sc1
    buffer_load_dwordx4 v[132:135], v7, s[40:43], s63 offen offset:1024 sc1
    buffer_load_dwordx4 v[136:139], v7, s[40:43], s63 offen offset:2048 sc1
    buffer_load_dwordx4 v[140:143], v7, s[40:43], s63 offen offset:3072 sc1
L_npo:
    s_waitcnt lgkmcnt(0)
    s_add_u32 s28, s28, 2654435761
    s_and_b32 s48, s28, 0xff
    s_bfe_u32 s49, s28, 0x80008
    s_bfe_u32 s50, s28, 0x80010
    s_lshr_b32 s51, s28, 24
    s_cmp_eq_u32 s3, 1
    s_cbranch_scc1 L_H1
    s_mov_b64 exec, 1
    ds_add_u32 v61, v62 offset:3080
    s_mov_b64 exec, -1
L_role:
    s_cmp_ge_u32 s30, 23
    s_cbranch_scc1 L_final
    s_cmp_ge_u32 s30, 16
    s_cbranch_scc1 L_hffn
    s_cmp_eq_u32 s3, 3
    s_cbranch_scc1 L_oml
    v_and_b32 v26, 1, v1
    v_lshl_add_u32 v26, v26, 2, v3
    v_lshlrev_b32 v26, 4, v26
    v_bfe_u32 v27, v1, 1, 2
    v_lshl_add_u32 v26, v27, 2, v26
    v_lshrrev_b32 v27, 3, v1
    v_lshlrev_b32 v27, 4, v27
    s_mov_b32 s52, 2097152
L_spin5:
    ds_read_b32 v24, v61 offset:3076
    s_waitcnt lgkmcnt(0)
    v_readfirstlane_b32 s53, v24
    s_cmp_eq_u32 s53, 8
    s_cbranch_scc1 L_sok5
    s_sleep 2
    s_sub_u32 s52, s52, 1
    s_cbranch_scc0 L_spin5
L_sok5:
    s_mov_b32 s52, 0x200000
L_cw6:
    ds_read_b32 v24, v61 offset:3100
    s_waitcnt lgkmcnt(0)
    v_readfirstlane_b32 s77, v24
    s_cmp_lg_u32 s77, 0
    s_cbranch_scc1 L_cwk6
    s_sleep 2
    s_sub_u32 s52, s52, 1
    s_cbranch_scc0 L_cw6
L_cwk6:
    s_mov_b32 s52, 20000
    s_cmp_eq_u32 s77, 2
    s_cselect_b32 s53, 0, -2359296
    s_add_u32 s62, s62, s53
    buffer_load_dwordx4 v[64:67], v7, s[40:43], s62 offen offset:0 sc1
    buffer_load_dwordx4 v[68:71], v7, s[40:43], s62 offen offset:1024 sc1
    buffer_load_dwordx4 v[72:75], v7, s[40:43], s62 offen offset:2048 sc1
    buffer_load_dwordx4 v[76:79], v7, s[40:43], s62 offen offset:3072 sc1
    s_sleep 3
L_pl7:
    buffer_load_dwordx4 v[80:83], v7, s[40:43], s62 offen offset:0 sc1
    buffer_load_dwordx4 v[84:87], v7, s[40:43], s62 offen offset:1024 sc1
    buffer_load_dwordx4 v[88:91], v7, s[40:43], s62 offen offset:2048 sc1
    buffer_load_dwordx4 v[92:95], v7, s[40:43], s62 offen offset:3072 sc1
    ds_read_b128 v[28:31], v27 offset:3456
    s_waitcnt vmcnt(7)
    v_xor_b32 v8, s48, v64
    v_xor_b32 v9, s49, v65
    v_xor_b32 v10, s50, v66
    v_xor_b32 v11, s51, v67
    v_or3_b32 v24, v8, v9, v10
    v_or_b32 v24, v24, v11
    s_waitcnt vmcnt(6)
    v_xor_b32 v12, s48, v68
    v_xor_b32 v13, s49, v69
    v_xor_b32 v14, s50, v70
    v_xor_b32 v15, s51, v71
    v_or3_b32 v24, v24, v12, v13
    v_or3_b32 v24, v24, v14, v15
    s_waitcnt vmcnt(5)
    v_xor_b32 v16, s48, v72
    v_xor_b32 v17, s49, v73
    v_xor_b32 v18, s50, v74
    v_xor_b32 v19, s51, v75
    v_or3_b32 v24, v24, v16, v17
    v_or3_b32 v24, v24, v18, v19
    s_waitcnt vmcnt(4)
    v_xor_b32 v20, s48, v76
    v_xor_b32 v21, s49, v77
    v_xor_b32 v22, s50, v78
    v_xor_b32 v23, s51, v79
    v_or3_b32 v24, v24, v20, v21
    v_or3_b32 v24, v24, v22, v23
    v_cmp_ne_u32_sdwa vcc, v24, v61 src0_sel:BYTE_0 src1_sel:DWORD
    s_cbranch_vccz L_ok7
    buffer_load_dwordx4 v[64:67], v7, s[40:43], s62 offen offset:0 sc1
    buffer_load_dwordx4 v[68:71], v7, s[40:43], s62 offen offset:1024 sc1
    buffer_load_dwordx4 v[72:75], v7, s[40:43], s62 offen offset:2048 sc1
    buffer_load_dwordx4 v[76:79], v7, s[40:43], s62 offen offset:3072 sc1
    ds_read_b128 v[28:31], v27 offset:3456
    s_waitcnt vmcnt(7)
    v_xor_b32 v8, s48, v80
    v_xor_b32 v9, s49, v81
    v_xor_b32 v10, s50, v82
    v_xor_b32 v11, s51, v83
    v_or3_b32 v24, v8, v9, v10
    v_or_b32 v24, v24, v11
    s_waitcnt vmcnt(6)
    v_xor_b32 v12, s48, v84
    v_xor_b32 v13, s49, v85
    v_xor_b32 v14, s50, v86
    v_xor_b32 v15, s51, v87
    v_or3_b32 v24, v24, v12, v13
    v_or3_b32 v24, v24, v14, v15
    s_waitcnt vmcnt(5)
    v_xor_b32 v16, s48, v88
    v_xor_b32 v17, s49, v89
    v_xor_b32 v18, s50, v90
    v_xor_b32 v19, s51, v91
    v_or3_b32 v24, v24, v16, v17
    v_or3_b32 v24, v24, v18, v19
    s_waitcnt vmcnt(4)
    v_xor_b32 v20, s48, v92
    v_xor_b32 v21, s49, v93
    v_xor_b32 v22, s50, v94
    v_xor_b32 v23, s51, v95
    v_or3_b32 v24, v24, v20, v21
    v_or3_b32 v24, v24, v22, v23
    v_cmp_ne_u32_sdwa vcc, v24, v61 src0_sel:BYTE_0 src1_sel:DWORD
    s_cbranch_vccz L_ok7
    s_sub_u32 s52, s52, 1
    s_cbranch_scc0 L_pl7
L_ok7:
    s_mov_b32 s52, 0x200000
L_wspin:
    s_waitcnt lgkmcnt(0)
    v_max3_u32 v24, v28, v29, v30
    v_pk_mul_f32 v[32:33], v[8:9], v[28:29] op_sel_hi:[1,0]
    v_max_u32 v24, v24, v31
    v_pk_mul_f32 v[34:35], v[10:11], v[28:29] op_sel_hi:[1,0]
    v_cmp_eq_u32 vcc, -1, v24
    v_pk_fma_f32 v[32:33], v[12:13], v[28:29], v[32:33] op_sel:[0,1,0] op_sel_hi:[1,1,1]
    v_pk_fma_f32 v[34:35], v[14:15], v[28:29], v[34:35] op_sel:[0,1,0] op_sel_hi:[1,1,1]
    v_pk_fma_f32 v[32:33], v[16:17], v[30:31], v[32:33] op_sel_hi:[1,0,1]
    v_pk_fma_f32 v[34:35], v[18:19], v[30:31], v[34:35] op_sel_hi:[1,0,1]
    v_pk_fma_f32 v[32:33], v[20:21], v[30:31], v[32:33] op_sel:[0,1,0] op_sel_hi:[1,1,1]
    v_pk_fma_f32 v[34:35], v[22:23], v[30:31], v[34:35] op_sel:[0,1,0] op_sel_hi:[1,1,1]
    s_cbranch_vccz L_wok
    ds_read_b128 v[28:31], v27 offset:3456
    s_sub_u32 s52, s52, 1
    s_cbranch_scc0 L_wspin
L_wok:
    s_nop 1
    v_permlane32_swap_b32 v32, v34
    v_permlane32_swap_b32 v33, v35
    s_nop 0
    v_add_f32 v32, v32, v34
    v_add_f32 v33, v33, v35
    s_nop 1
    v_permlane16_swap_b32 v32, v33
    s_nop 0
    v_add_f32 v36, v32, v33
    s_nop 1
    v_add_f32_dpp v36, v36, v36 row_ror:8 row_mask:0xf bank_mask:0xf
    v_cvt_pk_bf16_f32 v36, v36, v36
    ds_write_b32 v26, v36 offset:3328
    s_branch L_exit
L_stub13:
    s_branch L_ret2
L_oml:
    s_lshr_b32 s63, s30, 3
    s_lshl_b32 s63, s63, 9
    s_lshl_b32 s62, s29, 10
    s_add_u32 s62, s62, s63
    s_add_u32 s62, s62, 2400256
    v_and_b32 v26, 31, v1
    v_lshlrev_b32 v7, 4, v26
    v_and_b32 v27, 7, v1
    v_lshlrev_b32 v27, 4, v27
    v_lshrrev_b32 v26, 3, v26
    v_lshl_add_u32 v27, v26, 2, v27
    s_mov_b32 s52, 2097152
L_spin8:
    ds_read_b32 v24, v61 offset:3072
    s_waitcnt lgkmcnt(0)
    v_readfirstlane_b32 s53, v24
    s_cmp_eq_u32 s53, 8
    s_cbranch_scc1 L_sok8
    s_sleep 2
    s_sub_u32 s52, s52, 1
    s_cbranch_scc0 L_spin8
L_sok8:
    s_mov_b32 s52, 20000
    s_cmp_eq_u32 s77, 2
    s_cselect_b32 s53, 0, -2359296
    s_add_u32 s62, s62, s53
    buffer_load_dwordx4 v[64:67], v7, s[40:43], s62 offen sc1
    s_sleep 8
    buffer_load_dwordx4 v[68:71], v7, s[40:43], s62 offen sc1
    s_sleep 8
L_pl9:
    buffer_load_dwordx4 v[72:75], v7, s[40:43], s62 offen sc1
    s_waitcnt vmcnt(2)
    v_xor_b32 v8, s48, v64
    v_xor_b32 v9, s49, v65
    v_xor_b32 v10, s50, v66
    v_xor_b32 v11, s51, v67
    v_or3_b32 v24, v8, v9, v10
    v_or_b32 v24, v24, v11
    v_cmp_ne_u32_sdwa vcc, v24, v61 src0_sel:BYTE_0 src1_sel:DWORD
    s_cbranch_vccz L_ok9
    buffer_load_dwordx4 v[64:67], v7, s[40:43], s62 offen sc1
    s_waitcnt vmcnt(2)
    v_xor_b32 v8, s48, v68
    v_xor_b32 v9, s49, v69
    v_xor_b32 v10, s50, v70
    v_xor_b32 v11, s51, v71
    v_or3_b32 v24, v8, v9, v10
    v_or_b32 v24, v24, v11
    v_cmp_ne_u32_sdwa vcc, v24, v61 src0_sel:BYTE_0 src1_sel:DWORD
    s_cbranch_vccz L_ok9
    buffer_load_dwordx4 v[68:71], v7, s[40:43], s62 offen sc1
    s_waitcnt vmcnt(2)
    v_xor_b32 v8, s48, v72
    v_xor_b32 v9, s49, v73
    v_xor_b32 v10, s50, v74
    v_xor_b32 v11, s51, v75
    v_or3_b32 v24, v8, v9, v10
    v_or_b32 v24, v24, v11
    v_cmp_ne_u32_sdwa vcc, v24, v61 src0_sel:BYTE_0 src1_sel:DWORD
    s_cbranch_vccz L_ok9
    s_sub_u32 s52, s52, 1
    s_cbranch_scc0 L_pl9
L_ok9:
    v_mov_b32 v24, v8
    s_nop 1
    v_max_f32_dpp v24, v24, v24 quad_perm:[1,0,3,2] row_mask:0xf bank_mask:0xf
    s_nop 1
    v_max_f32_dpp v24, v24, v24 quad_perm:[2,3,0,1] row_mask:0xf bank_mask:0xf
    s_nop 1
    v_max_f32_dpp v24, v24, v24 row_half_mirror row_mask:0xf bank_mask:0xf
    s_nop 1
    v_max_f32_dpp v24, v24, v24 row_mirror row_mask:0xf bank_mask:0xf
    v_mov_b32 v25, v24
    s_nop 1
    v_permlane16_swap_b32 v24, v25
    s_nop 0
    v_max_f32 v24, v24, v25
    v_sub_f32 v8, v8, v24
    v_mul_f32 v8, s55, v8
    v_exp_f32 v8, v8
    s_nop 0
    v_mul_f32 v24, v8, v9
    s_nop 1
    v_add_f32_dpp v24, v24, v24 quad_perm:[1,0,3,2] row_mask:0xf bank_mask:0xf
    s_nop 1
    v_add_f32_dpp v24, v24, v24 quad_perm:[2,3,0,1] row_mask:0xf bank_mask:0xf
    s_nop 1
    v_add_f32_dpp v24, v24, v24 row_half_mirror row_mask:0xf bank_mask:0xf
    s_nop 1
    v_add_f32_dpp v24, v24, v24 row_mirror row_mask:0xf bank_mask:0xf
    v_mov_b32 v25, v24
    s_nop 1
    v_permlane16_swap_b32 v24, v25
    s_nop 0
    v_add_f32 v24, v24, v25
    v_rcp_f32 v24, v24
    s_nop 0
    v_mul_f32 v8, v8, v24
    ds_write_b32 v27, v8 offset:3456
    s_branch L_exit
L_hffn:
    s_cmp_eq_u32 s3, 3
    s_cbranch_scc1 L_exit
    s_mul_i32 s57, s29, 7
    s_add_u32 s57, s57, s30
    s_sub_u32 s57, s57, 16
    v_bfe_u32 v7, v1, 3, 2
    v_mul_u32_u24 v7, 7168, v7
    v_and_b32 v26, 7, v1
    v_lshl_add_u32 v7, v26, 4, v7
    s_lshl_b32 s62, s57, 7
    s_add_u32 s62, s62, 69632
    s_mov_b32 s52, 2097152
L_spin10:
    ds_read_b32 v24, v61 offset:3080
    s_waitcnt lgkmcnt(0)
    v_readfirstlane_b32 s53, v24
    s_cmp_eq_u32 s53, 19
    s_cbranch_scc1 L_sok10
    s_sleep 2
    s_sub_u32 s52, s52, 1
    s_cbranch_scc0 L_spin10
L_sok10:
    s_mov_b32 s52, 20000
L_pl11:
    buffer_load_dwordx4 v[64:67], v7, s[40:43], s62 offen sc1
    s_waitcnt vmcnt(0)
    v_xor_b32 v8, s48, v64
    v_xor_b32 v9, s49, v65
    v_xor_b32 v10, s50, v66
    v_xor_b32 v11, s51, v67
    v_or3_b32 v24, v8, v9, v10
    v_or_b32 v24, v24, v11
    v_cmp_ne_u32_sdwa vcc, v24, v61 src0_sel:BYTE_0 src1_sel:DWORD
    s_cbranch_vccz L_ok11
    s_sleep 2
    s_sub_u32 s52, s52, 1
    s_cbranch_scc0 L_pl11
L_ok11:
    s_nop 1
    v_add_f32_dpp v8, v8, v8 row_ror:8 row_mask:0xf bank_mask:0xf
    v_add_f32_dpp v9, v9, v9 row_ror:8 row_mask:0xf bank_mask:0xf
    v_add_f32_dpp v10, v10, v10 row_ror:8 row_mask:0xf bank_mask:0xf
    v_add_f32_dpp v11, v11, v11 row_ror:8 row_mask:0xf bank_mask:0xf
    v_cvt_pk_bf16_f32 v8, v8, v8
    v_lshlrev_b32 v8, 16, v8
    v_cvt_pk_bf16_f32 v9, v9, v9
    v_lshlrev_b32 v9, 16, v9
    v_cvt_pk_bf16_f32 v10, v10, v10
    v_lshlrev_b32 v10, 16, v10
    v_cvt_pk_bf16_f32 v11, v11, v11
    v_lshlrev_b32 v11, 16, v11
    v_mov_b32 v12, v8
    v_mov_b32 v13, v9
    v_mov_b32 v14, v10
    v_mov_b32 v15, v11
    s_nop 0
    v_permlane16_swap_b32 v8, v12
    v_permlane16_swap_b32 v9, v13
    v_permlane16_swap_b32 v10, v14
    v_permlane16_swap_b32 v11, v15
    s_mov_b32 s53, 0xbfb8aa3b
    v_mul_f32 v16, s53, v8
    v_mul_f32 v17, s53, v9
    v_mul_f32 v18, s53, v10
    v_mul_f32 v19, s53, v11
    v_exp_f32 v16, v16
    v_exp_f32 v17, v17
    v_exp_f32 v18, v18
    v_exp_f32 v19, v19
    v_add_f32 v16, 1.0, v16
    v_add_f32 v17, 1.0, v17
    v_add_f32 v18, 1.0, v18
    v_add_f32 v19, 1.0, v19
    v_rcp_f32 v16, v16
    v_rcp_f32 v17, v17
    v_rcp_f32 v18, v18
    v_rcp_f32 v19, v19
    v_mul_f32 v16, v8, v16
    v_mul_f32 v17, v9, v17
    v_mul_f32 v18, v10, v18
    v_mul_f32 v19, v11, v19
    v_cvt_pk_bf16_f32 v16, v16, v16
    v_lshlrev_b32 v16, 16, v16
    v_cvt_pk_bf16_f32 v17, v17, v17
    v_lshlrev_b32 v17, 16, v17
    v_cvt_pk_bf16_f32 v18, v18, v18
    v_lshlrev_b32 v18, 16, v18
    v_cvt_pk_bf16_f32 v19, v19, v19
    v_lshlrev_b32 v19, 16, v19
    v_mul_f32 v16, v16, v12
    v_mul_f32 v17, v17, v13
    v_mul_f32 v18, v18, v14
    v_mul_f32 v19, v19, v15
    v_cvt_pk_bf16_f32 v16, v16, v16
    v_cvt_pk_bf16_f32 v17, v17, v17
    v_cvt_pk_bf16_f32 v18, v18, v18
    v_cvt_pk_bf16_f32 v19, v19, v19
    v_and_b32 v27, 1, v26
    v_lshlrev_b32 v27, 6, v27
    v_lshrrev_b32 v26, 1, v26
    v_lshl_add_u32 v26, v26, 2, v27
    s_mov_b64 exec, 0xff
    ds_write_b32 v26, v16 offset:3328
    ds_write_b32 v26, v17 offset:3360
    ds_write_b32 v26, v18 offset:3344
    ds_write_b32 v26, v19 offset:3376
    s_branch L_exit
L_stub14:
    s_branch L_ret2
L_final:
    s_cmp_ge_u32 s30, 30
    s_cbranch_scc1 L_exit
    s_mul_i32 s57, s29, 7
    s_add_u32 s57, s57, s30
    s_sub_u32 s57, s57, 23
    v_lshrrev_b32 v7, 1, v1
    v_mul_u32_u24 v7, 256, v7
    v_and_b32 v26, 1, v1
    v_lshl_add_u32 v7, v26, 4, v7
    s_lshr_b32 s62, s57, 3
    s_lshl_b32 s62, s62, 17
    s_sub_u32 s63, 0, s40
    s_and_b32 s63, s63, 0x3fff
    s_add_u32 s62, s62, s63
    s_add_u32 s62, s62, 720896
    s_and_b32 s63, s57, 7
    s_lshl_b32 s64, s63, 5
    s_and_b32 s65, s63, 3
    s_lshl_b32 s65, s65, 11
    s_lshr_b32 s63, s63, 2
    s_lshl_b32 s63, s63, 14
    s_add_u32 s65, s65, s63
    s_add_u32 s65, s65, s62
    s_add_u32 s65, s65, 98304
    s_add_u32 s62, s62, s64
    v_and_b32 v27, 1, v3
    v_lshlrev_b32 v27, 1, v27
    v_lshrrev_b32 v28, 1, v3
    v_or_b32 v27, v27, v28
    v_mov_b32 v27, v3
    v_lshl_add_u32 v26, v26, 2, v27
    v_lshlrev_b32 v27, 3, v26
    s_mov_b32 s36, s4
    s_mov_b32 s37, s5
    s_mov_b32 s44, s22
    s_mov_b32 s45, s23
    s_mov_b32 s46, 896
    s_mov_b32 s47, 0x20000
    s_lshl_b32 s63, s57, 4
    v_lshl_add_u32 v28, v26, 1, s63
    buffer_load_ushort v29, v28, s[36:39], 0 offen
    s_lshl_b32 s63, s29, 16
    s_and_b32 s64, s30, 7
    s_lshl_b32 s64, s64, 12
    s_add_u32 s63, s63, s64
    s_add_u32 s63, s63, 163840
    v_lshrrev_b32 v30, 5, v1
    v_lshlrev_b32 v30, 15, v30
    v_and_b32 v31, 31, v1
    v_lshl_add_u32 v30, v31, 7, v30
    s_cmp_eq_u32 s3, 2
    s_cbranch_scc0 L_npr
    s_and_b32 s66, s57, 1
    s_lshl_b32 s64, s66, 13
    s_xor_b32 s67, s64, 8192
    s_add_u32 s64, s64, s65
    s_add_u32 s65, s65, s67
    s_getreg_b32 s67, hwreg(HW_REG_XCC_ID)
    s_lshr_b32 s67, s67, 2
    s_xor_b32 s66, s66, s67
    s_memtime s[4:5]
    s_waitcnt lgkmcnt(0)
    s_load_dword s10, s[26:27], s64 offset:0
    s_load_dword s11, s[26:27], s64 offset:128
    s_load_dword s12, s[26:27], s64 offset:256
    s_waitcnt lgkmcnt(0)
    s_memtime s[6:7]
    s_waitcnt lgkmcnt(0)
    s_load_dword s10, s[26:27], s65 offset:0
    s_load_dword s11, s[26:27], s65 offset:128
    s_load_dword s12, s[26:27], s65 offset:256
    s_waitcnt lgkmcnt(0)
    s_memtime s[8:9]
    s_waitcnt lgkmcnt(0)
    s_sub_u32 s8, s8, s6
    s_sub_u32 s6, s6, s4
    s_sub_u32 s4, s6, s8
    s_sub_u32 s5, s8, s6
    s_cmp_eq_u32 s66, 0
    s_cselect_b32 s4, s4, s5
    s_min_i32 s4, s4, 2047
    s_max_i32 s4, s4, -2047
    s_lshl_b32 s4, s4, 8
    v_mov_b32 v24, s4
    s_lshl_b32 s64, s57, 4
    s_add_u32 s64, s64, 36864
    s_mov_b32 s65, 36864
    v_lshlrev_b32 v25, 4, v1
    v_and_or_b32 v8, v24, v60, s48
    v_and_or_b32 v9, v61, v60, s49
    v_and_or_b32 v10, v61, v60, s50
    v_and_or_b32 v11, v61, v60, s51
    s_mov_b64 exec, 1
    buffer_store_dwordx4 v[8:11], v61, s[40:43], s64 offen sc1
    s_mov_b64 exec, -1
L_vnp:
    s_mov_b32 s52, 0x20000
L_vw:
    ds_read_b32 v24, v61 offset:3080
    s_waitcnt lgkmcnt(0)
    v_readfirstlane_b32 s53, v24
    s_cmp_ge_u32 s53, 16
    s_cbranch_scc1 L_vwk
    s_sleep 4
    s_sub_u32 s52, s52, 1
    s_cbranch_scc0 L_vw
L_vwk:
    s_mov_b32 s52, 2
    v_cmp_gt_u32 s[4:5], 56, v1
L_vg:
    buffer_load_dwordx4 v[8:11], v25, s[40:43], s65 offen sc1
    s_waitcnt vmcnt(0)
    v_xor_b32 v8, s48, v8
    v_xor_b32 v9, s49, v9
    v_xor_b32 v10, s50, v10
    v_xor_b32 v11, s51, v11
    v_or3_b32 v24, v8, v9, v10
    v_or_b32 v24, v24, v11
    v_cmp_eq_u32_sdwa vcc, v24, v61 src0_sel:BYTE_0 src1_sel:DWORD
    s_and_b64 vcc, vcc, s[4:5]
    s_bcnt1_i32_b64 s53, vcc
    s_cmp_ge_u32 s53, 48
    s_cbranch_scc1 L_vgk
    s_sleep 8
    s_sub_u32 s52, s52, 1
    s_cbranch_scc0 L_vg
L_vgk:
    v_ashrrev_i32 v8, 8, v8
    v_cndmask_b32 v8, 0, v8, vcc
    s_nop 1
    v_add_u32_dpp v8, v8, v8 quad_perm:[1,0,3,2] row_mask:0xf bank_mask:0xf
    s_nop 1
    v_add_u32_dpp v8, v8, v8 quad_perm:[2,3,0,1] row_mask:0xf bank_mask:0xf
    s_nop 1
    v_add_u32_dpp v8, v8, v8 row_half_mirror row_mask:0xf bank_mask:0xf
    s_nop 1
    v_add_u32_dpp v8, v8, v8 row_mirror row_mask:0xf bank_mask:0xf
    v_mov_b32 v9, v8
    s_nop 1
    v_permlane16_swap_b32 v8, v9
    s_nop 0
    v_add_u32 v8, v8, v9
    v_mov_b32 v9, v8
    s_nop 1
    v_permlane32_swap_b32 v8, v9
    s_nop 0
    v_add_u32 v8, v8, v9
    v_readfirstlane_b32 s66, v8
    s_cmp_gt_i32 s66, 0
    s_cselect_b32 s66, 1, 0
    s_xor_b32 s66, s66, s67
    s_lshl_b32 s66, s66, 13
    s_add_u32 s66, s66, 1
    v_mov_b32 v24, s66
    ds_write_b32 v61, v24 offset:3108
L_npr:
    s_mov_b32 s52, 2097152
L_spin12:
    ds_read_b32 v24, v61 offset:3076
    s_waitcnt lgkmcnt(0)
    v_readfirstlane_b32 s53, v24
    s_cmp_eq_u32 s53, 8
    s_cbranch_scc1 L_sok12
    s_sleep 2
    s_sub_u32 s52, s52, 1
    s_cbranch_scc0 L_spin12
L_sok12:
    s_mov_b32 s52, 64
L_nw:
    ds_read_b32 v24, v61 offset:3108
    s_waitcnt lgkmcnt(0)
    v_readfirstlane_b32 s66, v24
    s_cmp_lg_u32 s66, 0
    s_cbranch_scc1 L_nwk
    s_sub_u32 s52, s52, 1
    s_cbranch_scc0 L_nw
L_nwk:
    s_and_b32 s66, s66, 8192
    s_add_u32 s62, s62, s66
    s_mov_b32 s52, 0x200000
L_cw13:
    ds_read_b32 v24, v61 offset:3100
    s_waitcnt lgkmcnt(0)
    v_readfirstlane_b32 s77, v24
    s_cmp_lg_u32 s77, 0
    s_cbranch_scc1 L_cwk13
    s_sleep 2
    s_sub_u32 s52, s52, 1
    s_cbranch_scc0 L_cw13
L_cwk13:
    s_cmp_lg_u32 s77, 1
    s_cbranch_scc1 L_fg
    s_mov_b32 s52, 40
L_pl14:
    buffer_load_dwordx4 v[128:131], v30, s[40:43], s63 offen sc1
    s_waitcnt vmcnt(0)
    v_xor_b32 v8, s48, v128
    v_xor_b32 v9, s49, v129
    v_xor_b32 v10, s50, v130
    v_xor_b32 v11, s51, v131
    v_or3_b32 v24, v8, v9, v10
    v_or_b32 v24, v24, v11
    v_cmp_ne_u32_sdwa vcc, v24, v61 src0_sel:BYTE_0 src1_sel:DWORD
    s_cbranch_vccz L_ok14
    s_sleep 2
    s_sub_u32 s52, s52, 1
    s_cbranch_scc0 L_pl14
L_ok14:
L_fg:
    s_branch L_skip30
L_stub15:
    s_branch L_ret2
L_skip30:
    s_cmp_eq_u32 s3, 3
    s_cbranch_scc0 L_fin_s
    s_add_u32 s62, s62, 65536
    s_add_u32 s63, s62, 16384
    v_cmp_gt_u32 s[60:61], 48, v1
    v_subrev_u32 v28, 6144, v7
    s_nop 1
    v_cndmask_b32 v28, v28, v7, s[60:61]
    s_mov_b32 s52, 20000
    buffer_load_dwordx4 v[64:67], v7, s[40:43], s62 offen sc1
    buffer_load_dwordx4 v[68:71], v28, s[40:43], s63 offen sc1
    s_sleep 4
    buffer_load_dwordx4 v[72:75], v7, s[40:43], s62 offen sc1
    buffer_load_dwordx4 v[76:79], v28, s[40:43], s63 offen sc1
    s_sleep 4
L_pl15:
    buffer_load_dwordx4 v[80:83], v7, s[40:43], s62 offen sc1
    buffer_load_dwordx4 v[84:87], v28, s[40:43], s63 offen sc1
    s_waitcnt vmcnt(5)
    v_xor_b32 v8, s48, v64
    v_xor_b32 v9, s49, v65
    v_xor_b32 v10, s50, v66
    v_xor_b32 v11, s51, v67
    v_or3_b32 v24, v8, v9, v10
    v_or_b32 v24, v24, v11
    s_waitcnt vmcnt(4)
    v_xor_b32 v12, s48, v68
    v_xor_b32 v13, s49, v69
    v_xor_b32 v14, s50, v70
    v_xor_b32 v15, s51, v71
    v_or3_b32 v24, v24, v12, v13
    v_or3_b32 v24, v24, v14, v15
    v_cmp_ne_u32_sdwa vcc, v24, v61 src0_sel:BYTE_0 src1_sel:DWORD
    s_cbranch_vccz L_ok15
    buffer_load_dwordx4 v[64:67], v7, s[40:43], s62 offen sc1
    buffer_load_dwordx4 v[68:71], v28, s[40:43], s63 offen sc1
    s_branch L_skip32
    .p2align 12
L_stub16:
    s_branch L_ret2
L_skip32:
    s_waitcnt vmcnt(5)
    v_xor_b32 v8, s48, v72
    v_xor_b32 v9, s49, v73
    v_xor_b32 v10, s50, v74
    v_xor_b32 v11, s51, v75
    v_or3_b32 v24, v8, v9, v10
    v_or_b32 v24, v24, v11
    s_waitcnt vmcnt(4)
    v_xor_b32 v12, s48, v76
    v_xor_b32 v13, s49, v77
    v_xor_b32 v14, s50, v78
    v_xor_b32 v15, s51, v79
    v_or3_b32 v24, v24, v12, v13
    v_or3_b32 v24, v24, v14, v15
    v_cmp_ne_u32_sdwa vcc, v24, v61 src0_sel:BYTE_0 src1_sel:DWORD
    s_cbranch_vccz L_ok15
    buffer_load_dwordx4 v[72:75], v7, s[40:43], s62 offen sc1
    buffer_load_dwordx4 v[76:79], v28, s[40:43], s63 offen sc1
    s_waitcnt vmcnt(5)
    v_xor_b32 v8, s48, v80
    v_xor_b32 v9, s49, v81
    v_xor_b32 v10, s50, v82
    v_xor_b32 v11, s51, v83
    v_or3_b32 v24, v8, v9, v10
    v_or_b32 v24, v24, v11
    s_waitcnt vmcnt(4)
    v_xor_b32 v12, s48, v84
    v_xor_b32 v13, s49, v85
    v_xor_b32 v14, s50, v86
    v_xor_b32 v15, s51, v87
    v_or3_b32 v24, v24, v12, v13
    v_or3_b32 v24, v24, v14, v15
    v_cmp_ne_u32_sdwa vcc, v24, v61 src0_sel:BYTE_0 src1_sel:DWORD
    s_cbranch_vccz L_ok15
    s_sub_u32 s52, s52, 1
    s_cbranch_scc0 L_pl15
L_ok15:
    v_cndmask_b32 v12, 0, v12, s[60:61]
    v_cndmask_b32 v13, 0, v13, s[60:61]
    v_cndmask_b32 v14, 0, v14, s[60:61]
    v_cndmask_b32 v15, 0, v15, s[60:61]
    v_add_f32 v8, v8, v12
    v_add_f32 v9, v9, v13
    v_add_f32 v10, v10, v14
    v_add_f32 v11, v11, v15
    s_nop 1
    v_permlane32_swap_b32 v8, v10
    v_permlane32_swap_b32 v9, v11
    s_nop 0
    v_add_f32 v8, v8, v10
    v_add_f32 v9, v9, v11
    s_nop 1
    v_permlane16_swap_b32 v8, v9
    s_nop 0
    v_add_f32 v16, v8, v9
    s_nop 1
    v_add_f32_dpp v16, v16, v16 row_ror:8 row_mask:0xf bank_mask:0xf
    s_nop 1
    v_add_f32_dpp v16, v16, v16 row_ror:4 row_mask:0xf bank_mask:0xf
    s_nop 1
    v_add_f32_dpp v16, v16, v16 quad_perm:[2,3,0,1] row_mask:0xf bank_mask:0xf
    v_cvt_pk_bf16_f32 v16, v16, v16
    v_lshlrev_b32 v16, 16, v16
    v_mul_f32 v18, 0xbfb8aa3b, v16
    v_exp_f32 v18, v18
    s_nop 0
    v_add_f32 v18, 1.0, v18
    v_rcp_f32 v18, v18
    s_nop 0
    v_mul_f32 v16, v16, v18
    v_cvt_pk_bf16_f32 v16, v16, v16
    v_lshlrev_b32 v16, 16, v16
    v_mov_b32 v17, 1
    ds_write_b64 v27, v[16:17] offset:3584
    s_branch L_exit
L_fin_s:
    s_add_u32 s63, s62, 16384
    s_add_u32 s64, s62, 32768
    s_add_u32 s65, s62, 49152
    s_mov_b32 s60, 0x00030003
    s_mov_b32 s61, 0x00030003
    s_waitcnt vmcnt(0)
    v_lshlrev_b32 v29, 16, v29
    s_mov_b32 s52, 20000
    buffer_load_dwordx4 v[64:67], v7, s[40:43], s62 offen sc1
    buffer_load_dwordx4 v[68:71], v7, s[40:43], s63 offen sc1
    buffer_load_dwordx4 v[72:75], v7, s[40:43], s64 offen sc1
    buffer_load_dwordx4 v[76:79], v7, s[40:43], s65 offen sc1
    s_sleep 4
    buffer_load_dwordx4 v[80:83], v7, s[40:43], s62 offen sc1
    buffer_load_dwordx4 v[84:87], v7, s[40:43], s63 offen sc1
    buffer_load_dwordx4 v[88:91], v7, s[40:43], s64 offen sc1
    buffer_load_dwordx4 v[92:95], v7, s[40:43], s65 offen sc1
    s_sleep 4
L_pl16:
    buffer_load_dwordx4 v[96:99], v7, s[40:43], s62 offen sc1
    buffer_load_dwordx4 v[100:103], v7, s[40:43], s63 offen sc1
    buffer_load_dwordx4 v[104:107], v7, s[40:43], s64 offen sc1
    buffer_load_dwordx4 v[108:111], v7, s[40:43], s65 offen sc1
    s_waitcnt vmcnt(11)
    v_xor_b32 v8, s48, v64
    v_xor_b32 v9, s49, v65
    v_xor_b32 v10, s50, v66
    v_xor_b32 v11, s51, v67
    v_or3_b32 v24, v8, v9, v10
    v_or_b32 v24, v24, v11
    s_waitcnt vmcnt(10)
    v_xor_b32 v12, s48, v68
    v_xor_b32 v13, s49, v69
    v_xor_b32 v14, s50, v70
    v_xor_b32 v15, s51, v71
    v_or3_b32 v24, v24, v12, v13
    v_or3_b32 v24, v24, v14, v15
    s_waitcnt vmcnt(9)
    v_xor_b32 v16, s48, v72
    v_xor_b32 v17, s49, v73
    v_xor_b32 v18, s50, v74
    v_xor_b32 v19, s51, v75
    v_or3_b32 v24, v24, v16, v17
    v_or3_b32 v24, v24, v18, v19
    s_waitcnt vmcnt(8)
    v_xor_b32 v20, s48, v76
    v_xor_b32 v21, s49, v77
    v_xor_b32 v22, s50, v78
    v_xor_b32 v23, s51, v79
    v_or3_b32 v24, v24, v20, v21
    v_or3_b32 v24, v24, v22, v23
    v_cmp_ne_u32_sdwa vcc, v24, v61 src0_sel:BYTE_0 src1_sel:DWORD
    s_cbranch_vccz L_ok16
    buffer_load_dwordx4 v[64:67], v7, s[40:43], s62 offen sc1
    buffer_load_dwordx4 v[68:71], v7, s[40:43], s63 offen sc1
    buffer_load_dwordx4 v[72:75], v7, s[40:43], s64 offen sc1
    buffer_load_dwordx4 v[76:79], v7, s[40:43], s65 offen sc1
    s_waitcnt vmcnt(11)
    v_xor_b32 v8, s48, v80
    v_xor_b32 v9, s49, v81
    v_xor_b32 v10, s50, v82
    v_xor_b32 v11, s51, v83
    v_or3_b32 v24, v8, v9, v10
    v_or_b32 v24, v24, v11
    s_waitcnt vmcnt(10)
    v_xor_b32 v12, s48, v84
    v_xor_b32 v13, s49, v85
    v_xor_b32 v14, s50, v86
    v_xor_b32 v15, s51, v87
    v_or3_b32 v24, v24, v12, v13
    v_or3_b32 v24, v24, v14, v15
    s_waitcnt vmcnt(9)
    v_xor_b32 v16, s48, v88
    v_xor_b32 v17, s49, v89
    v_xor_b32 v18, s50, v90
    v_xor_b32 v19, s51, v91
    v_or3_b32 v24, v24, v16, v17
    v_or3_b32 v24, v24, v18, v19
    s_waitcnt vmcnt(8)
    v_xor_b32 v20, s48, v92
    v_xor_b32 v21, s49, v93
    v_xor_b32 v22, s50, v94
    v_xor_b32 v23, s51, v95
    v_or3_b32 v24, v24, v20, v21
    v_or3_b32 v24, v24, v22, v23
    v_cmp_ne_u32_sdwa vcc, v24, v61 src0_sel:BYTE_0 src1_sel:DWORD
    s_cbranch_vccz L_ok16
    buffer_load_dwordx4 v[80:83], v7, s[40:43], s62 offen sc1
    buffer_load_dwordx4 v[84:87], v7, s[40:43], s63 offen sc1
    buffer_load_dwordx4 v[88:91], v7, s[40:43], s64 offen sc1
    buffer_load_dwordx4 v[92:95], v7, s[40:43], s65 offen sc1
    s_branch L_skip37
L_stub17:
    s_branch L_ret2
L_skip37:
    s_waitcnt vmcnt(11)
    v_xor_b32 v8, s48, v96
    v_xor_b32 v9, s49, v97
    v_xor_b32 v10, s50, v98
    v_xor_b32 v11, s51, v99
    v_or3_b32 v24, v8, v9, v10
    v_or_b32 v24, v24, v11
    s_waitcnt vmcnt(10)
    v_xor_b32 v12, s48, v100
    v_xor_b32 v13, s49, v101
    v_xor_b32 v14, s50, v102
    v_xor_b32 v15, s51, v103
    v_or3_b32 v24, v24, v12, v13
    v_or3_b32 v24, v24, v14, v15
    s_waitcnt vmcnt(9)
    v_xor_b32 v16, s48, v104
    v_xor_b32 v17, s49, v105
    v_xor_b32 v18, s50, v106
    v_xor_b32 v19, s51, v107
    v_or3_b32 v24, v24, v16, v17
    v_or3_b32 v24, v24, v18, v19
    s_waitcnt vmcnt(8)
    v_xor_b32 v20, s48, v108
    v_xor_b32 v21, s49, v109
    v_xor_b32 v22, s50, v110
    v_xor_b32 v23, s51, v111
    v_or3_b32 v24, v24, v20, v21
    v_or3_b32 v24, v24, v22, v23
    v_cmp_ne_u32_sdwa vcc, v24, v61 src0_sel:BYTE_0 src1_sel:DWORD
    s_cbranch_vccz L_ok16
    s_sub_u32 s52, s52, 1
    s_cbranch_scc0 L_pl16
L_ok16:
    ds_read_b64 v[32:33], v27 offset:3584
    v_pk_add_f32 v[8:9], v[8:9], v[12:13]
    v_pk_add_f32 v[10:11], v[10:11], v[14:15]
    v_pk_add_f32 v[16:17], v[16:17], v[20:21]
    v_pk_add_f32 v[18:19], v[18:19], v[22:23]
    v_pk_add_f32 v[8:9], v[8:9], v[16:17]
    v_pk_add_f32 v[10:11], v[10:11], v[18:19]
    s_nop 1
    v_permlane32_swap_b32 v8, v10
    v_permlane32_swap_b32 v9, v11
    s_nop 0
    v_add_f32 v8, v8, v10
    v_add_f32 v9, v9, v11
    s_nop 1
    v_permlane16_swap_b32 v8, v9
    s_nop 0
    v_add_f32 v16, v8, v9
    s_waitcnt lgkmcnt(0)
    v_cmp_ne_u32 vcc, 1, v33
    v_add_f32_dpp v16, v16, v16 row_ror:8 row_mask:0xf bank_mask:0xf
    s_nop 1
    v_add_f32_dpp v16, v16, v16 row_ror:4 row_mask:0xf bank_mask:0xf
    s_nop 1
    v_add_f32_dpp v16, v16, v16 quad_perm:[2,3,0,1] row_mask:0xf bank_mask:0xf
    v_cvt_pk_bf16_f32 v16, v61, v16
    s_cbranch_vccnz L_g2slow
L_g2ok:
    v_mul_f32 v18, v16, v32
    v_cvt_pk_bf16_f32 v18, v61, v18
    v_add_f32 v16, v29, v18
    v_cvt_pk_bf16_f32 v16, v16, v16
    s_mov_b64 exec, s[60:61]
    buffer_store_short v16, v28, s[44:47], 0 offen
    s_cmp_eq_u32 s57, 0
    s_cbranch_scc0 L_exit
    s_mov_b64 exec, 1
    v_mov_b32 v17, s28
    buffer_store_dword v17, v61, s[40:43], 0 offen sc1
L_exit:
L_end:
    s_endpgm
L_g2slow:
    s_mov_b32 s52, 0x200000
L_g2spin:
    ds_read_b64 v[32:33], v27 offset:3584
    s_waitcnt lgkmcnt(0)
    v_cmp_ne_u32 vcc, 1, v33
    s_cbranch_vccz L_g2ok
    s_sub_u32 s52, s52, 1
    s_cbranch_scc0 L_g2spin
    s_branch L_g2ok
.section .rodata,"a"
.p2align 6
.amdhsa_kernel recurrent_scan__sliding_block_cached__swiglu_ffn__decode_kernel
  .amdhsa_next_free_vgpr 168
  .amdhsa_next_free_sgpr 102
  .amdhsa_accum_offset 168
  .amdhsa_group_segment_fixed_size 0
  .amdhsa_kernarg_size 96
  .amdhsa_user_sgpr_count 2
  .amdhsa_user_sgpr_kernarg_segment_ptr 1
  .amdhsa_system_sgpr_workgroup_id_x 1
.end_amdhsa_kernel
```
